```python
import torch

def _softmax(x, axis=-1):
    return torch.softmax(x, dim=axis)
def _gelu(x):
    return torch.nn.functional.gelu(x, approximate="tanh")
def _silu(x):
    return torch.nn.functional.silu(x)
def _sigmoid(x):
    return torch.sigmoid(x)
def _layernorm(x, axis=-1, eps=1e-5):
    m = x.mean(dim=axis, keepdim=True)
    v = x.var(dim=axis, keepdim=True, unbiased=False)
    return (x - m) / torch.sqrt(v + eps)
def _scatter_add(tgt, idx, src, axis=0):
    return tgt.clone().index_add_(axis, idx, src)
def _segment_sum(src, seg, n):
    out = torch.zeros((n,) + src.shape[1:], dtype=src.dtype)
    return out.index_add_(0, seg, src)
def _pad(x, pw):
    flat = tuple(v for pair in reversed(pw) for v in pair)
    return torch.nn.functional.pad(x, flat)

kernel_name = 'gather_scatter__cheap_equivariant_egnn__graph'

def setup_inputs():

    _w = (lambda a: (lambda t: t.to(torch.bfloat16) if t.is_floating_point() else t)(torch.as_tensor(a)))
    N, deg, D, De = 10000, 32, 128, max(0, 1)
    E = N * deg
    return {
        "h": _w((lambda *s: torch.randn(*s, dtype=torch.bfloat16) * 0.2)(N, D)),
        "pos": _w((lambda *s: torch.randn(*s, dtype=torch.bfloat16) * 0.8)(N, 3)),
        "e_attr": _w((lambda *s: torch.randn(*s, dtype=torch.bfloat16) * 0.8)(E, De)),
        "src": _w((lambda lo, hi, *s: torch.randint(lo, hi, s))(0, N, E).to(torch.int64)),
        "dst": _w((lambda lo, hi, *s: torch.randint(lo, hi, s))(0, N, E).to(torch.int64)),
        "w_e": _w(0.1 * (lambda *s: torch.randn(*s, dtype=torch.bfloat16) * 0.8)(2 * D + 1 + De, D)),
        "w_x": _w(0.1 * (lambda *s: torch.randn(*s, dtype=torch.bfloat16) * 0.2)(D, 1)),
        "w_h": _w(0.1 * (lambda *s: torch.randn(*s, dtype=torch.bfloat16) * 0.2)(2 * D, D)),
    }

def reference(h, pos, e_attr, src, dst, w_e, w_x, w_h):
    N, D = h.shape[0], h.shape[1]
    diff = pos[dst] - pos[src]
    dist2 = torch.sum(diff * diff, axis=-1, keepdims=True)
    e_in = torch.concatenate([h[dst], h[src], dist2, e_attr], axis=-1)
    m_ij = _silu(e_in @ w_e)
    coord_scale = m_ij @ w_x
    pos_new = pos + _segment_sum(diff * coord_scale, dst, N)
    m_i = _segment_sum(m_ij, dst, N)
    h_new = h + _silu(torch.concatenate([h, m_i], axis=-1) @ w_h)
    return h_new, pos_new
```

```asm
; @launch kernel=kf_kernel grid=(256,1,1) block=(768,1,1) lds=162560
.amdgcn_target "amdgcn-amd-amdhsa--gfx950"
.text
.globl kf_kernel
.p2align 8
.type kf_kernel,@function
kf_kernel:
    s_load_dwordx2 s[22:23], s[0:1], 80
    s_load_dwordx16 s[4:19], s[0:1], 0
    s_load_dwordx2 s[20:21], s[0:1], 64
    s_load_dwordx2 s[68:69], s[0:1], 72
    s_cmp_ge_u32 s2, 256
    s_cbranch_scc1 L2_exit
    v_lshrrev_b32 v1, 6, v0
    v_lshlrev_b32 v167, 4, v0
    v_readfirstlane_b32 s24, v1
    v_and_b32 v164, 63, v0
    s_cmp_ge_u32 s2, 96
    s_cbranch_scc1 L1_gemm
    s_mul_i32 s72, s2, 13344
    s_add_u32 s73, s72, 12288
    s_add_u32 s76, s72, 13344
    s_min_u32 s76, s76, 1280000
    v_lshl_add_u32 v4, v0, 2, s73
    v_add_u32 v3, s72, v167
    v_cmp_gt_u32 s[64:65], s76, v4
    v_lshrrev_b32 v5, 1, v3
    v_lshrrev_b32 v6, 1, v4
    v_mov_b64 v[24:25], 0
    v_mov_b64 v[26:27], 0
    s_waitcnt lgkmcnt(0)
    s_mov_b64 exec, s[64:65]
    s_cbranch_execz L1_nold
    global_load_dword v12, v4, s[12:13]
    global_load_dword v18, v4, s[10:11]
    global_load_ushort v22, v6, s[8:9]
L1_nold:
    s_mov_b64 exec, -1
    global_load_dwordx4 v[8:11], v3, s[12:13]
    global_load_dwordx4 v[14:17], v3, s[10:11]
    global_load_dwordx2 v[20:21], v5, s[8:9]
    v_lshlrev_b32 v2, 2, v0
    v_add_u32 v3, 58624, v167
    ds_write_b32 v2, v24 offset:55552
    ds_write_b128 v3, v[24:27]
    ds_write_b128 v3, v[24:27] offset:12288
    ds_write_b128 v3, v[24:27] offset:24576
    v_mov_b32 v23, 33
    v_mov_b32 v80, 0
    s_mov_b32 s60, s22
    s_mov_b32 s61, s23
    s_mov_b32 s62, 3190784
    s_mov_b32 s63, 0x00020000
    v_lshrrev_b32 v28, 3, v0
    v_and_b32 v29, 7, v0
    v_lshlrev_b32 v29, 4, v29
    v_mul_u32_u24 v30, 144, v28
    v_mul_u32_u24 v28, 12416, v28
    v_add_u32 v28, v28, v29
    v_add_u32 v30, v30, v29
    v_add_u32 v30, 57088, v30
    v_add_u32 v31, 93952, v29
    s_waitcnt lgkmcnt(0)
    s_barrier
    v_mov_b64 v[108:109], 0
    v_mov_b64 v[110:111], 0
    v_lshrrev_b32 v1, 1, v167
    ds_write_b128 v167, v[108:111] offset:0
    ds_write_b128 v167, v[108:111] offset:12288
    ds_write_b128 v167, v[108:111] offset:24576
    ds_write_b128 v167, v[108:111] offset:36864
    v_cmp_eq_u32 vcc, 5536, v1
    v_mov_b32 v44, 0
    v_mov_b32 v45, 0x1000000
    v_cndmask_b32 v45, 0, v45, vcc
    v_cmp_gt_u32 vcc, 5632, v1
    s_mov_b64 exec, vcc
    ds_write_b64 v1, v[44:45] offset:49152
    s_mov_b64 exec, -1
    s_mul_i32 s3, s2, 625
    s_add_u32 s70, s3, 640
    s_add_u32 s3, s3, 15
    s_lshr_b32 s3, s3, 4
    s_lshr_b32 s70, s70, 4
    s_sub_u32 s70, s70, s3
    s_lshl_b32 s71, s3, 8
    s_lshl_b32 s54, s70, 8
    s_mov_b32 s55, 0x00020000
    s_add_u32 s52, s4, s71
    s_addc_u32 s53, s5, 0
    s_lshl_b32 s34, s24, 10
    s_mov_b32 s44, s6
    s_mov_b32 s45, s7
    s_mov_b32 s46, 60000
    s_mov_b32 s47, 0x00020000
    s_mov_b32 s29, 0
    s_mov_b32 s30, 0
    s_mov_b32 s50, 131072
    s_mov_b32 s51, 0x00020000
    s_add_u32 s48, s22, 16777216
    s_addc_u32 s49, s23, 0
    s_and_b32 s25, s24, 1
    s_bfe_u32 s26, s24, 0x10001
    s_lshr_b32 s27, s24, 2
    s_mul_i32 s31, s24, 4192
    s_mov_b32 s77, 115200
    s_cmp_eq_u32 s27, 0
    s_cselect_b32 s77, s77, 51840
    s_cselect_b32 s57, 1, 0
    s_add_u32 s31, s31, s77
    s_lshl_b32 s85, s25, 7
    s_add_u32 s85, s85, 12578816
    s_add_u32 s40, s22, s85
    s_addc_u32 s41, s23, 16777216
    s_mov_b32 s42, 2563968
    s_mov_b32 s43, 0x00020000
    v_mov_b32 v165, 16
    v_mov_b32 v166, 0x3f80
    v_mov_b32 v24, 0
    s_mov_b32 s58, 0
    s_lshl_b32 s76, s2, 7
    s_add_u32 s77, s76, 12288
    s_add_u32 s78, s77, 1191936
    s_add_u32 s79, s77, 2383872
    s_mov_b32 s80, 429497
    s_movk_i32 s81, 625
    s_mov_b32 s82, 3216550459
    s_mov_b32 s83, 3216550459
    s_mov_b32 s84, 0x05040100
    s_mov_b32 s85, 0x07060100
    s_movk_i32 s86, 792
    s_waitcnt vmcnt(2)
    v_mul_u32_u24 v64, s80, v8
    v_lshrrev_b32 v64, 24, v64
    v_lshlrev_b32 v70, 2, v64
    ds_add_rtn_u32 v76, v70, v23 offset:55552
    v_mul_u32_u24 v65, s80, v9
    v_lshrrev_b32 v65, 24, v65
    v_lshlrev_b32 v71, 2, v65
    ds_add_rtn_u32 v77, v71, v23 offset:55552
    v_mul_u32_u24 v66, s80, v10
    v_lshrrev_b32 v66, 24, v66
    v_lshlrev_b32 v72, 2, v66
    ds_add_rtn_u32 v78, v72, v23 offset:55552
    v_mul_u32_u24 v67, s80, v11
    v_lshrrev_b32 v67, 24, v67
    v_lshlrev_b32 v73, 2, v67
    ds_add_rtn_u32 v79, v73, v23 offset:55552
    s_mov_b64 exec, s[64:65]
    s_cbranch_execz L1_x1
    v_mul_u32_u24 v68, s80, v12
    v_lshrrev_b32 v68, 24, v68
    v_lshlrev_b32 v74, 2, v68
    ds_add_rtn_u32 v80, v74, v23 offset:55552
L1_x1:
    s_mov_b64 exec, -1
    v_mad_u32_u24 v82, v64, s81, -1
    v_ashrrev_i32 v82, 4, v82
    v_sub_u32 v8, v8, v82
    v_mul_u32_u24 v64, 144, v64
    v_mad_u32_u24 v83, v65, s81, -1
    v_ashrrev_i32 v83, 4, v83
    v_sub_u32 v9, v9, v83
    v_mul_u32_u24 v65, 144, v65
    v_mad_u32_u24 v84, v66, s81, -1
    v_ashrrev_i32 v84, 4, v84
    v_sub_u32 v10, v10, v84
    v_mul_u32_u24 v66, 144, v66
    v_mad_u32_u24 v85, v67, s81, -1
    v_ashrrev_i32 v85, 4, v85
    v_sub_u32 v11, v11, v85
    v_mul_u32_u24 v67, 144, v67
    v_mad_u32_u24 v86, v68, s81, -1
    v_ashrrev_i32 v86, 4, v86
    v_sub_u32 v12, v12, v86
    v_mul_u32_u24 v68, 144, v68
    s_waitcnt vmcnt(1)
    v_lshlrev_b32 v14, 6, v14
    v_add_lshl_u32 v8, v14, v8, 2
    v_lshlrev_b32 v15, 6, v15
    v_add_lshl_u32 v9, v15, v9, 2
    v_lshlrev_b32 v16, 6, v16
    v_add_lshl_u32 v10, v16, v10, 2
    v_lshlrev_b32 v17, 6, v17
    v_add_lshl_u32 v11, v17, v11, 2
    v_lshlrev_b32 v18, 6, v18
    v_add_lshl_u32 v12, v18, v12, 2
    v_lshlrev_b32 v86, 16, v22
    s_waitcnt vmcnt(0)
    v_lshlrev_b32 v82, 16, v20
    v_and_b32 v83, 0xffff0000, v20
    v_lshlrev_b32 v84, 16, v21
    v_and_b32 v85, 0xffff0000, v21
    v_mul_f32 v86, s82, v86
    v_pk_mul_f32 v[82:83], v[82:83], s[82:83]
    v_pk_mul_f32 v[84:85], v[84:85], s[82:83]
    v_cvt_pk_bf16_f32 v22, v86, v86
    v_cvt_pk_bf16_f32 v20, v82, v83
    v_cvt_pk_bf16_f32 v21, v84, v85
    v_perm_b32 v14, v20, v8, s84
    v_perm_b32 v15, v20, v9, s85
    v_perm_b32 v16, v21, v10, s84
    v_perm_b32 v17, v21, v11, s85
    v_perm_b32 v18, v22, v12, s84
    s_waitcnt lgkmcnt(0)
    v_max3_u32 v82, v76, v77, v78
    v_max3_u32 v82, v82, v79, v80
    v_cmp_le_u32 vcc, s86, v82
    s_cbranch_vccnz L1_ovf
L1_ovf_done:
    v_bfe_u32 v82, v76, 3, 5
    v_bfe_u32 v76, v76, 3, 2
    v_lshl_add_u32 v82, v82, 2, v64
    v_mad_i32_i24 v76, v76, -3, v82
    ds_write_b32 v82, v14 offset:57088
    ds_write_b8_d16_hi v76, v8 offset:57100
    v_bfe_u32 v83, v77, 3, 5
    v_bfe_u32 v77, v77, 3, 2
    v_lshl_add_u32 v83, v83, 2, v65
    v_mad_i32_i24 v77, v77, -3, v83
    ds_write_b32 v83, v15 offset:57088
    ds_write_b8_d16_hi v77, v9 offset:57100
    v_bfe_u32 v84, v78, 3, 5
    v_bfe_u32 v78, v78, 3, 2
    v_lshl_add_u32 v84, v84, 2, v66
    v_mad_i32_i24 v78, v78, -3, v84
    ds_write_b32 v84, v16 offset:57088
    ds_write_b8_d16_hi v78, v10 offset:57100
    v_bfe_u32 v85, v79, 3, 5
    v_bfe_u32 v79, v79, 3, 2
    v_lshl_add_u32 v85, v85, 2, v67
    v_mad_i32_i24 v79, v79, -3, v85
    ds_write_b32 v85, v17 offset:57088
    ds_write_b8_d16_hi v79, v11 offset:57100
    s_mov_b64 exec, s[64:65]
    s_cbranch_execz L1_x2
    v_bfe_u32 v86, v80, 3, 5
    v_bfe_u32 v80, v80, 3, 2
    v_lshl_add_u32 v86, v86, 2, v68
    v_mad_i32_i24 v80, v80, -3, v86
    ds_write_b32 v86, v18 offset:57088
    ds_write_b8_d16_hi v80, v12 offset:57100
L1_x2:
    s_mov_b64 exec, -1
    s_cmp_gt_u32 s24, 7
    s_waitcnt lgkmcnt(0)
    s_barrier
    ds_read_b128 v[64:67], v30
    ds_read_b128 v[68:71], v30 offset:13824
    s_cbranch_scc1 L1_no3
    ds_read_b128 v[72:75], v30 offset:27648
    s_waitcnt lgkmcnt(0)
    buffer_store_dwordx4 v[72:75], v28, s[60:63], s79 offen sc1
L1_no3:
    s_cmp_lg_u32 s24, 11
    s_cbranch_scc1 L1_noov
    ds_read_b128 v[72:75], v31
    s_mov_b64 exec, 0xff
    s_waitcnt lgkmcnt(0)
    buffer_store_dwordx4 v[72:75], v29, s[60:63], s76 offen sc1
    s_mov_b64 exec, -1
L1_noov:
    s_waitcnt lgkmcnt(0)
    buffer_store_dwordx4 v[64:67], v28, s[60:63], s77 offen sc1
    buffer_store_dwordx4 v[68:71], v28, s[60:63], s78 offen sc1
L1_end:
    v_and_b32 v23, 7, v164
    v_lshlrev_b32 v23, 2, v23
    s_cmp_lg_u32 s24, 0
    s_cbranch_scc1 L2_ngo
    global_load_dword v26, v23, s[68:69] sc1
L2_ngo:
L2_batch:
    s_load_dwordx2 s[68:69], s[0:1], 72
    v_lshlrev_b32 v30, 4, v164
    v_lshlrev_b32 v29, 2, v164
    v_and_b32 v119, 15, v164
    v_lshrrev_b32 v120, 4, v164
    v_xor_b32 v121, v119, v120
    v_lshlrev_b32 v121, 4, v121
    v_lshl_add_u32 v48, v119, 8, v121
    v_and_b32 v121, 3, v164
    v_lshlrev_b32 v121, 2, v121
    v_add_lshl_u32 v121, v121, v120, 4
    v_lshl_add_u32 v50, v119, 8, v121
    s_add_u32 s60, s22, 12582912
    s_addc_u32 s61, s23, 0
    s_mov_b32 s62, 16777216
    s_mov_b32 s63, 0x00020000
    s_mul_i32 s76, s2, 12416
    s_add_u32 s76, s76, 12288
    s_add_u32 s32, s22, s76
    s_addc_u32 s33, s23, 0
    s_add_u32 s76, s2, 1
    s_lshl_b32 s76, s76, 8
    s_movk_i32 s77, 256
    s_mov_b32 s81, 0x0c0c0401
    s_mov_b32 s82, 0x0c0c0501
    s_mov_b32 s83, 0x0c0c0601
    s_mov_b32 s79, 0xffffff
    s_sub_u32 s72, 23, s24
    s_lshl_b32 s72, s72, 10
    v_add_u32 v28, s72, v30
    s_lshl_b32 s84, s24, 3
    v_and_or_b32 v27, v164, 7, s84
    s_mul_i32 s85, s24, 20
    s_add_u32 s85, s85, 16
    s_cmp_lt_u32 s24, 4
    s_cselect_b32 s85, 253, s85
    v_min_u32 v22, 19, v164
    v_add_u32 v22, s85, v22
    v_min_u32 v22, 255, v22
    s_getreg_b32 s84, hwreg(HW_REG_XCC_ID)
    s_and_b32 s84, s84, 7
    s_lshl_b32 s84, s84, 14
    s_add_u32 s84, s84, 18874368
    s_mov_b32 s86, 0
    v_lshl_add_u32 v27, v27, 6, s84
    v_lshl_add_u32 v31, v22, 6, s84
    s_or_b32 s85, s24, s29
    s_lshl_b32 s87, s2, 6
    s_add_u32 s87, s87, 18874368
    s_cmp_lt_u32 s2, 96
    s_waitcnt vmcnt(0) lgkmcnt(0)
    s_cbranch_scc1 L2_y0
    s_waitcnt vmcnt(0)
L2_y0:
    s_cmp_lg_u32 s85, 0
    s_cbranch_scc1 L2_y
L2_zq:
    v_cmp_eq_u32 vcc, 0, v26
    s_add_u32 s86, s86, 1
    s_cmp_gt_u32 s86, 32768
    s_cbranch_vccz L2_y
    s_cbranch_scc1 L2_y
    global_load_dword v26, v23, s[68:69] sc1
    s_waitcnt vmcnt(0)
    s_branch L2_zq
L2_y:
    s_cmp_lg_u32 s29, 0
    s_barrier
    s_cbranch_scc1 L2_p1
    s_or_b32 s85, s24, s58
    s_cbranch_scc1 L2_nfl
    v_lshl_add_u32 v23, v164, 14, s87
    s_mov_b64 exec, 255
    global_store_dword v23, v165, s[22:23] sc1
    s_mov_b64 exec, -1
L2_nfl:
    s_cmp_ge_u32 s2, 96
    s_cbranch_scc1 L2_bst
    v_lshlrev_b32 v112, 4, v164
    v_lshrrev_b32 v113, 4, v0
    v_xor_b32 v114, v113, v0
    v_and_b32 v114, 15, v114
    v_lshlrev_b32 v114, 4, v114
    v_lshl_add_u32 v113, v113, 8, v114
    s_cmp_lg_u32 s24, 11
    s_cbranch_scc1 L2_nwr1
    v_and_b32 v114, 16, v164
    v_lshlrev_b32 v114, 2, v114
    v_xor_b32 v114, v114, v112
    v_add_u32 v115, -512, v112
    s_add_u32 s94, s14, 65536
    s_addc_u32 s95, s15, 0
    s_mov_b32 m0, 67840
    s_mov_b32 exec_hi, 0
    global_load_lds_dwordx4 v114, s[94:95]
    s_mov_b32 exec_lo, 0
    s_mov_b32 exec_hi, 0xffff
    global_load_lds_dwordx4 v115, s[16:17]
    s_mov_b64 exec, -1
L2_nwr1:
    s_add_u32 m0, s34, 55552
    s_nop 0
    buffer_load_dwordx4 v113, s[52:55], 0 offen lds
    s_mul_i32 s89, s24, 5120
    s_add_u32 m0, s89, 102144
    s_nop 0
    buffer_load_dwordx4 v112, s[44:47], s89 offen offset:0 lds
    buffer_load_dwordx4 v112, s[44:47], s89 offen offset:1024 lds
    buffer_load_dwordx4 v112, s[44:47], s89 offen offset:2048 lds
    buffer_load_dwordx4 v112, s[44:47], s89 offen offset:3072 lds
    s_add_u32 s89, s89, 4096
    s_min_u32 s89, s89, 59392
    s_add_u32 m0, s89, 102144
    s_nop 0
    buffer_load_dwordx4 v112, s[44:47], s89 offen lds
L2_cl:
    v_and_b32 v119, 31, v164
    v_lshrrev_b32 v116, 5, v164
    v_lshlrev_b32 v120, 3, v116
    v_sub_u32 v119, v119, v120
    v_and_b32 v120, 1, v119
    v_lshlrev_b32 v120, 4, v120
    v_lshlrev_b32 v120, v120, v166
    v_ashrrev_i32 v119, 1, v119
    v_cmp_eq_u32 vcc, 0, v119
    s_nop 1
    v_cndmask_b32 v128, 0, v120, vcc
    v_cmp_eq_u32 vcc, 1, v119
    s_nop 1
    v_cndmask_b32 v129, 0, v120, vcc
    v_cmp_eq_u32 vcc, 2, v119
    s_nop 1
    v_cndmask_b32 v130, 0, v120, vcc
    v_cmp_eq_u32 vcc, 3, v119
    s_nop 1
    v_cndmask_b32 v131, 0, v120, vcc
    v_cmp_eq_u32 vcc, 8, v119
    s_nop 1
    v_cndmask_b32 v132, 0, v120, vcc
    v_cmp_eq_u32 vcc, 9, v119
    s_nop 1
    v_cndmask_b32 v133, 0, v120, vcc
    v_cmp_eq_u32 vcc, 10, v119
    s_nop 1
    v_cndmask_b32 v134, 0, v120, vcc
    v_cmp_eq_u32 vcc, 11, v119
    s_nop 1
    v_cndmask_b32 v135, 0, v120, vcc
    v_and_b32 v119, 7, v164
    v_xor_b32 v120, v119, v116
    v_lshlrev_b32 v157, 4, v120
    v_mov_b32 v156, 0xdddddddd
    v_and_b32 v121, 8, v164
    v_and_b32 v122, 3, v164
    v_lshl_add_u32 v122, v122, 1, v121
    v_bfe_u32 v121, v164, 4, 1
    v_add_u32 v122, v122, v121
    v_bfe_u32 v123, v164, 2, 1
    v_lshl_add_u32 v122, v122, 1, v123
    v_xor_b32 v123, 1, v116
    v_mul_u32_u24 v123, 29952, v123
    v_lshl_add_u32 v158, v122, 4, v123
    v_lshrrev_b32 v123, 3, v122
    v_mul_u32_u24 v123, 1056, v123
    v_and_b32 v122, 7, v122
    v_lshl_add_u32 v123, v122, 7, v123
    v_and_b32 v120, 1, v120
    v_lshl_add_u32 v161, v120, 4, v123
    v_lshrrev_b32 v120, 3, v164
    v_lshlrev_b32 v160, 4, v120
    v_and_b32 v119, 3, v164
    v_lshl_add_u32 v117, v121, 2, v119
    v_bfe_u32 v118, v164, 2, 2
    v_lshl_add_u32 v121, v116, 2, v118
    v_lshl_add_u32 v159, v121, 6, 8
    v_lshlrev_b32 v162, 2, v117
    v_sub_u32 v163, 28, v162
    s_lshl_b32 s80, s25, 1
    v_sub_u32 v144, 7, v118
    v_lshlrev_b32 v144, 8, v144
    v_mov_b32 v145, 0xfffff800
    v_add_u32 v119, 3, v118
    v_sub_u32 v119, v119, v116
    v_and_b32 v119, 3, v119
    v_xor_b32 v119, s80, v119
    v_lshl_add_u32 v119, v118, 2, v119
    v_lshlrev_b32 v119, 6, v119
    v_lshl_add_u32 v146, v117, 3, v119
    v_add_u32 v147, 1024, v146
    s_mov_b32 exec_lo, 0
    v_mov_b32 v145, 0
    v_add_u32 v146, 67328, v146
    v_mov_b32 v147, 54704
    s_mov_b32 exec_hi, 0x00ff00ff
    v_mov_b32 v146, 54704
    s_mov_b64 exec, -1
    v_add_u32 v161, s31, v161
    v_mov_b32 v149, v157
    v_mov_b32 v151, v157
    v_mov_b32 v153, v157
    v_mov_b32 v155, v157
L2_ngh:
    s_cmp_lg_u32 s24, 11
    s_cbranch_scc1 L2_nnl
    s_mul_i32 s94, s3, 6
    v_mul_u32_u24 v114, 6, v164
    v_mov_b64 v[104:105], 0
    v_mov_b64 v[106:107], 0
    buffer_load_short_d16_hi v104, v114, s[44:47], s94 offen
    buffer_load_short_d16_hi v105, v114, s[44:47], s94 offen offset:2
    buffer_load_short_d16_hi v106, v114, s[44:47], s94 offen offset:4
L2_nnl:
    s_cmp_lg_u32 s58, 0
    s_cbranch_scc1 L2_ack
L2_poll:
    global_load_dword v26, v27, s[22:23] sc1
L2_pollw:
    s_add_u32 s86, s86, 1
    s_waitcnt vmcnt(0)
L2_pollc:
    s_cmp_gt_u32 s86, 32768
    v_cmp_eq_u32 vcc, 0, v26
    s_cbranch_scc1 L2_polld
    s_cbranch_vccz L2_polld
    s_sleep 1
    s_branch L2_poll
L2_polld:
    global_load_dwordx4 v[2:5], v167, s[32:33] sc1
    global_load_dwordx4 v[6:9], v167, s[22:23] sc1
    s_cmp_lg_u32 s24, 11
    s_cbranch_scc1 L2_nnt
    s_mov_b32 exec_hi, 0xffff
    ds_write_b128 v30, v[104:107] offset:54784
    s_mov_b32 exec_hi, -1
L2_nnt:
L2_p1:
    s_waitcnt vmcnt(0)
L2_p1b:
    v_cmp_ne_u32 s[60:61], 0, v2
    v_cmp_ne_u32 s[62:63], 0, v3
    v_cmp_ne_u32 s[14:15], 0, v4
    v_and_b32 v10, 0xfc, v2
    v_and_b32 v11, 0xfc, v3
    v_and_b32 v12, 0xfc, v4
    s_mov_b64 exec, s[60:61]
    ds_add_rtn_u32 v15, v10, v165 offset:54528
    s_mov_b64 exec, s[62:63]
    ds_add_rtn_u32 v16, v11, v165 offset:54528
    s_mov_b64 exec, s[14:15]
    ds_add_rtn_u32 v17, v12, v165 offset:54528
    s_mov_b64 exec, -1
    v_xor_b32 v7, s76, v7
    v_xor_b32 v9, s76, v9
    v_cmp_gt_u32 s[66:67], s77, v7
    v_cmp_gt_u32 s[68:69], s77, v9
    v_cmp_lt_u32 vcc, s79, v5
    v_perm_b32 v96, v5, v2, s81
    v_mov_b32 v97, v2
    v_perm_b32 v98, v5, v3, s82
    v_mov_b32 v99, v3
    v_perm_b32 v100, v5, v4, s83
    v_mov_b32 v101, v4
    s_or_b64 s[84:85], s[66:67], s[68:69]
    s_cselect_b32 s90, 1, 0
    s_or_b64 s[84:85], s[84:85], vcc
    s_cbranch_scc1 L2_ov1
L2_ov1_done:
    s_waitcnt lgkmcnt(0)
    s_barrier
    ds_read_b32 v21, v29 offset:54528
    s_cmp_lg_u32 s57, 0
    s_cbranch_scc1 L2_secG
    s_waitcnt lgkmcnt(0)
    v_add_u32_dpp v20, v21, v21 row_shr:1 row_mask:0xf bank_mask:0xf bound_ctrl:0
    s_nop 0
    s_mov_b32 s84, 4096
    v_add_u32_dpp v20, v20, v20 row_shr:2 row_mask:0xf bank_mask:0xf bound_ctrl:0
    s_mov_b32 s85, 3040
    s_mov_b32 s86, 1984
    v_add_u32_dpp v20, v20, v20 row_shr:4 row_mask:0xf bank_mask:0xf bound_ctrl:0
    s_mov_b32 s87, 928
    s_mov_b32 s88, 512
    v_add_u32_dpp v20, v20, v20 row_shr:8 row_mask:0xf bank_mask:0xf bound_ctrl:0
    s_lshl_b32 s32, s24, 15
    s_add_u32 s32, s32, 8192
    v_add_u32_dpp v20, v20, v20 row_bcast:15 row_mask:0xa bank_mask:0xf
    s_add_u32 s33, s32, 16384
    s_lshl_b32 s35, s24, 6
    v_add_u32_dpp v20, v20, v20 row_bcast:31 row_mask:0xc bank_mask:0xf
    v_sub_u32 v21, v20, v21
    ds_bpermute_b32 v10, v10, v21
    ds_bpermute_b32 v11, v11, v21
    ds_bpermute_b32 v12, v12, v21
    v_readlane_b32 s80, v20, 40
    v_readlane_b32 s81, v20, 16
    v_readlane_b32 s82, v20, 24
    s_cmp_gt_u32 s80, 24576
    s_cbranch_scc1 L2_goslow
    s_cmp_lg_u32 s90, 0
    s_cbranch_scc1 L2_ov2
L2_ov2_done:
    global_load_dword v51, v31, s[22:23] sc1
    s_add_u32 s83, s80, 1023
    s_lshr_b32 s83, s83, 10
    s_lshl_b32 s83, s83, 9
    s_add_u32 s79, s80, 511
    s_andn2_b32 s79, s79, 511
    s_cmp_eq_u32 s26, 0
    s_cselect_b32 s76, 0, s83
    s_cselect_b32 s77, s83, s79
    v_cmp_ge_u32 vcc, s76, v20
    s_min_u32 s78, s83, s80
    s_cmp_lt_u32 s82, s78
    s_cselect_b32 s73, 1, s29
    s_cmp_gt_u32 s81, s83
    s_cselect_b32 s73, 1, s73
    s_min_u32 s78, s77, s80
    s_bcnt1_i32_b64 s28, vcc
    s_add_u32 s79, s28, 7
    s_cmp_lg_u32 s73, 0
    v_readlane_b32 s81, v20, s79
    s_cbranch_scc1 L2_fixed
    s_andn2_b32 s82, s81, 511
    s_min_u32 s82, s82, s77
    v_cmp_ge_u32 vcc, s82, v20
    s_cmp_eq_u32 s27, 1
    s_cselect_b32 s94, s76, s82
    s_bcnt1_i32_b64 s83, vcc
    s_add_u32 s79, s83, 7
    v_readlane_b32 s64, v20, s79
    s_andn2_b32 s65, s64, 511
    s_min_u32 s65, s65, s77
    v_cmp_ge_u32 vcc, s65, v20
    s_mov_b32 s66, s82
    s_mov_b32 s67, s65
    s_bcnt1_i32_b64 s68, vcc
    s_add_u32 s79, s68, 7
    v_readlane_b32 s69, v20, s79
    s_cmp_lt_u32 s69, s78
    s_cbranch_scc1 L2_chfix
L2_chsel:
    s_cmp_eq_u32 s27, 1
    s_cselect_b32 s95, s66, s67
    s_cselect_b32 s28, s28, s83
    s_cmp_eq_u32 s27, 0
    s_cselect_b32 s94, s65, s94
    s_cselect_b32 s95, s77, s95
    s_cselect_b32 s28, s68, s28
L2_chdone:
    s_lshl_b32 s79, s28, 2
    s_movk_i32 s81, -32
    v_add_u32 v23, s79, v163
    v_and_or_b32 v23, v23, s81, v162
    v_min_u32 v23, 164, v23
    ds_bpermute_b32 v162, v23, v21
    ds_bpermute_b32 v163, v23, v20
    s_waitcnt lgkmcnt(2)
    s_mov_b64 exec, s[60:61]
    v_add_u32 v15, v15, v10
    ds_write_b64 v15, v[96:97]
    s_mov_b64 exec, s[62:63]
    v_add_u32 v16, v16, v11
    ds_write_b64 v16, v[98:99]
    s_mov_b64 exec, s[14:15]
    v_add_u32 v17, v17, v12
    ds_write_b64 v17, v[100:101]
    s_mov_b64 exec, -1
    v_add_u32 v160, s94, v160
    s_mov_b32 s82, 102144
    s_mov_b32 s83, 0x0000bf80
    s_mov_b32 s56, 0xbf800000
    s_waitcnt vmcnt(0)
    v_cmp_eq_u32 vcc, 0, v51
    s_cbranch_vccnz L2_poll2
L2_poll2d:
    s_mov_b32 m0, s31
    s_waitcnt lgkmcnt(0)
    s_barrier
    ds_read_b64 v[2:3], v167
    ds_read_b64 v[4:5], v28
    ds_read_b32 v148, v160 offset:0
    ds_read_b32 v150, v160 offset:128
    ds_read_b32 v152, v160 offset:256
    ds_read_b32 v154, v160 offset:384
    s_min_u32 s58, s95, s80
    s_sub_u32 s95, s95, s94
    s_lshr_b32 s95, s95, 9
    s_lshl_b32 s79, s28, 8
    s_add_u32 s79, s79, 55296
    s_sub_u32 s78, s79, 1024
    v_add_u32 v16, s79, v144
    v_add_u32 v17, s78, v144
    v_add_u32 v158, s94, v158
    v_lshlrev_b32 v22, 5, v23
    v_and_or_b32 v16, v16, v145, v146
    v_and_or_b32 v17, v17, v145, v147
    v_add3_u32 v159, v159, v22, s94
    v_xor_b32 v18, 64, v16
    v_xor_b32 v19, 64, v17
    v_add_u32 v29, 102144, v167
    s_mov_b32 s75, s95
    s_waitcnt lgkmcnt(5)
    v_mad_u32_u24 v6, v2, 6, s82
    v_bfe_u32 v26, v3, 2, 6
    v_and_b32 v6, -4, v6
    v_lshlrev_b32 v7, 4, v26
    ds_read2_b32 v[44:45], v6 offset0:0 offset1:1
    ds_read_b96 v[10:12], v7 offset:54768
    v_lshlrev_b32 v13, 4, v2
    s_cmp_ge_u32 s72, s80
    s_waitcnt lgkmcnt(2)
    s_cbranch_scc1 L2_nod1
    v_mad_u32_u24 v8, v4, 6, s82
    v_bfe_u32 v27, v5, 2, 6
    v_and_b32 v8, -4, v8
    v_lshlrev_b32 v9, 4, v27
    ds_read2_b32 v[24:25], v8 offset0:0 offset1:1
    ds_read_b96 v[46:48], v9 offset:54768
    v_lshlrev_b32 v14, 4, v4
L2_nod1:
    s_cmp_eq_u32 s27, 0
    s_cbranch_scc1 L2_late0
    buffer_load_dwordx4 v[148:149], s[40:43], s84 idxen offen offset:0 sc1 lds
    buffer_load_dwordx4 v[150:151], s[40:43], s85 idxen offen offset:1056 sc1 lds
    buffer_load_dwordx4 v[152:153], s[40:43], s86 idxen offen offset:2112 sc1 lds
    buffer_load_dwordx4 v[154:155], s[40:43], s87 idxen offen offset:3168 sc1 lds
    ds_read_b32 v148, v160 offset:512
    ds_read_b32 v150, v160 offset:640
    ds_read_b32 v152, v160 offset:768
    ds_read_b32 v154, v160 offset:896
L2_late0:
    s_movk_i32 s78, -56
    s_movk_i32 s79, 72
    v_cmp_le_u32 s[60:61], s94, v162
    v_cmp_ge_u32 s[62:63], s58, v163
    v_cmp_gt_u32 s[64:65], s58, v162
    v_cmp_lt_u32 s[66:67], s94, v163
    v_add_u32 v163, -16, v163
    v_and_b32 v162, 0xffffffc0, v162
    v_and_b32 v163, 0xffffffc0, v163
    v_add3_u32 v162, v162, v22, s78
    v_add3_u32 v163, v163, v22, s79
    v_cmp_ne_u32 s[76:77], 0, v3
    v_bfe_u32 v6, v3, 1, 4
    v_add_u32 v6, v6, v167
    v_lshl_add_u32 v7, v26, 7, v167
    s_waitcnt lgkmcnt(0)
    v_alignbit_b32 v44, v45, v44, v13
    v_lshrrev_b32 v45, v13, v45
    v_dot2_f32_bf16 v10, v44, s83, v10
    v_dot2_f32_bf16 v11, v44, s56, v11
    v_dot2_f32_bf16 v12, v45, s83, v12
    s_nop 0
    v_cvt_pk_bf16_f32 v2, 1.0, v10
    s_nop 0
    v_cvt_pk_bf16_f32 v3, v11, v12
    v_dot2_f32_bf16 v10, v2, v2, -1.0
    v_dot2_f32_bf16 v10, v3, v3, v10
    s_mov_b64 exec, s[76:77]
    ds_write_b16 v6, v166 offset:29952
    ds_write_b64 v7, v[2:3] offset:8
    v_mul_f32 v10, 3216550459, v10
    v_cvt_pk_bf16_f32 v10, v10, v10
    ds_write_b16 v167, v10 offset:4
    s_mov_b64 exec, -1
    s_cmp_ge_u32 s72, s80
    s_cbranch_scc1 L2_nod2
    v_cmp_ne_u32 s[78:79], 0, v5
    v_bfe_u32 v8, v5, 1, 4
    v_add_u32 v8, v8, v28
    v_lshl_add_u32 v9, v27, 7, v28
    v_alignbit_b32 v24, v25, v24, v14
    v_lshrrev_b32 v25, v14, v25
    v_dot2_f32_bf16 v46, v24, s83, v46
    v_dot2_f32_bf16 v47, v24, s56, v47
    v_dot2_f32_bf16 v48, v25, s83, v48
    s_nop 0
    v_cvt_pk_bf16_f32 v4, 1.0, v46
    s_nop 0
    v_cvt_pk_bf16_f32 v5, v47, v48
    v_dot2_f32_bf16 v46, v4, v4, -1.0
    v_dot2_f32_bf16 v46, v5, v5, v46
    s_mov_b64 exec, s[78:79]
    ds_write_b16 v8, v166 offset:29952
    ds_write_b64 v9, v[4:5] offset:8
    v_mul_f32 v46, 3216550459, v46
    v_cvt_pk_bf16_f32 v46, v46, v46
    ds_write_b16 v28, v46 offset:4
    s_mov_b64 exec, -1
L2_nod2:
L2_b3:
    s_cmp_lg_u32 s27, 0
    s_waitcnt lgkmcnt(0)
    s_barrier
    s_cbranch_scc1 L2_w1
    buffer_load_dwordx4 v[148:149], s[40:43], s84 idxen offen offset:0 sc1 lds
    buffer_load_dwordx4 v[150:151], s[40:43], s85 idxen offen offset:1056 sc1 lds
    buffer_load_dwordx4 v[152:153], s[40:43], s86 idxen offen offset:2112 sc1 lds
    buffer_load_dwordx4 v[154:155], s[40:43], s87 idxen offen offset:3168 sc1 lds
    ds_read_b32 v148, v160 offset:512
    ds_read_b32 v150, v160 offset:640
    ds_read_b32 v152, v160 offset:768
    ds_read_b32 v154, v160 offset:896
    v_lshrrev_b32 v96, 4, v167
    s_add_u32 m0, s34, 133632
    v_and_b32 v96, 0xf0, v96
    s_movk_i32 s76, 8192
    v_xor_b32 v96, v96, v167
    buffer_load_dwordx4 v96, s[52:55], 0 offen lds
    s_add_u32 m0, s34, 137728
    s_nop 0
    buffer_load_dwordx4 v96, s[52:55], s84 offen lds
    s_add_u32 m0, s34, 141824
    s_nop 0
    buffer_load_dwordx4 v96, s[52:55], s76 offen lds
    s_mov_b32 m0, s31
L2_w1:
    ds_read_b64_tr_b16 v[136:137], v16
    ds_read_b64_tr_b16 v[138:139], v17
    ds_read_b128 v[144:147], v158
    ds_read_b64_tr_b16 v[140:141], v18
    ds_read_b64_tr_b16 v[142:143], v19
    v_mov_b64 v[120:121], 0
    v_mov_b64 v[122:123], 0
    s_waitcnt vmcnt(0)
    ds_read_b128 v[96:99], v161 offset:0
    ds_read_b128 v[100:103], v161 offset:32
    ds_read_b128 v[104:107], v161 offset:64
    ds_read_b128 v[108:111], v161 offset:96
    ds_write_b128 v29, v[120:123]
    s_mov_b64 exec, 1
    ds_add_u32 v120, v165 offset:54780
    s_mov_b64 exec, -1
    s_cmp_gt_u32 s29, 1
    s_cbranch_scc1 L2_noz
    v_mfma_f32_32x32x16_bf16 v[64:79], v[120:123], v[120:123], 0
    v_mfma_f32_32x32x16_bf16 v[80:95], v[120:123], v[120:123], 0
L2_noz:
    v_mfma_f32_32x32x16_bf16 v[48:63], v[120:123], v[120:123], 0
    v_mov_b64 v[124:125], 0
    v_mov_b64 v[126:127], 0
    s_mov_b32 s76, 0x3e803e80
    s_mov_b32 s77, 0x3e803e80
    v_mov_b64 v[112:113], s[76:77]
    v_mov_b64 v[114:115], s[76:77]
    v_add_u32 v160, 1024, v160
    s_cmp_eq_u32 s27, 0
    s_cselect_b32 s80, 0, 3
    s_cmp_eq_u32 s95, 0
    s_waitcnt lgkmcnt(2)
    s_cbranch_scc1 L2_zero
    s_setprio 3
    s_cmp_lg_u32 s27, 0
    s_cbranch_scc1 L2_p3
    s_setprio 2
L2_p3:
    s_cmp_lt_u32 s95, 2
    s_cbranch_scc1 L2_nodma1
    buffer_load_dwordx4 v[148:149], s[40:43], s84 idxen offen offset:0 sc1 lds
    buffer_load_dwordx4 v[150:151], s[40:43], s85 idxen offen offset:1056 sc1 lds
    buffer_load_dwordx4 v[152:153], s[40:43], s86 idxen offen offset:2112 sc1 lds
    buffer_load_dwordx4 v[154:155], s[40:43], s87 idxen offen offset:3168 sc1 lds
L2_nodma1:
    v_mfma_f32_32x32x16_bf16 v[0:15], v[96:99], v[128:131], 0
    v_mfma_f32_32x32x16_bf16 v[0:15], v[100:103], v[132:135], v[0:15]
    v_mfma_f32_32x32x16_bf16 v[0:15], v[144:147], v[136:139], v[0:15]
    s_nop 9
    s_cbranch_scc1 L2_last
    .p2align 6
L2_loop:
    v_mfma_f32_32x32x16_bf16 v[16:31], v[104:107], v[128:131], 0
    v_exp_f32 v32, v0
    v_exp_f32 v33, v1
    v_exp_f32 v34, v2
    v_mfma_f32_32x32x16_bf16 v[16:31], v[108:111], v[132:135], v[16:31]
    v_exp_f32 v35, v3
    v_exp_f32 v36, v4
    v_exp_f32 v37, v5
    v_mfma_f32_32x32x16_bf16 v[16:31], v[144:147], v[140:143], v[16:31]
    v_exp_f32 v38, v6
    v_exp_f32 v39, v7
    v_exp_f32 v40, v8
    v_exp_f32 v41, v9
    v_smfmac_f32_32x32x32_bf16 v[80:95], v[120:123], v[48:55], v156
    v_exp_f32 v42, v10
    v_exp_f32 v43, v11
    v_exp_f32 v44, v12
    v_exp_f32 v45, v13
    v_smfmac_f32_32x32x32_bf16 v[80:95], v[124:127], v[56:63], v156
    v_exp_f32 v46, v14
    v_exp_f32 v47, v15
    v_exp_f32 v48, v16
    v_exp_f32 v49, v17
    v_mfma_f32_32x32x16_bf16 v[32:47], v[112:115], v[112:115], v[32:47]
    v_exp_f32 v50, v18
    v_exp_f32 v51, v19
    v_exp_f32 v52, v20
    v_exp_f32 v53, v21
    v_med3_i32 v126, v159, v162, v163
    ds_read_b64_tr_b16 v[120:121], v126 offset:0
    ds_read_b64_tr_b16 v[122:123], v126 offset:16
    ds_read_b64_tr_b16 v[124:125], v126 offset:32
    ds_read_b64_tr_b16 v[126:127], v126 offset:48
    v_exp_f32 v54, v22
    v_exp_f32 v55, v23
    v_exp_f32 v56, v24
    v_exp_f32 v57, v25
    ds_read_b128 v[144:147], v158 offset:512
    ds_read_b32 v148, v160 offset:0
    ds_read_b32 v150, v160 offset:128
    ds_read_b32 v152, v160 offset:256
    ds_read_b32 v154, v160 offset:384
    v_exp_f32 v58, v26
    v_exp_f32 v59, v27
    v_exp_f32 v60, v28
    v_exp_f32 v61, v29
    v_add_u32 v158, s88, v158
    v_add_u32 v159, s88, v159
    v_add_u32 v160, s88, v160
    v_exp_f32 v62, v30
    v_exp_f32 v63, v31
    v_rcp_f32 v32, v32
    v_rcp_f32 v33, v33
    v_mfma_f32_32x32x16_bf16 v[48:63], v[112:115], v[112:115], v[48:63]
    v_rcp_f32 v34, v34
    v_rcp_f32 v35, v35
    s_waitcnt vmcnt(0)
    ds_read_b128 v[96:99], v161 offset:0
    ds_read_b128 v[100:103], v161 offset:32
    ds_read_b128 v[104:107], v161 offset:64
    ds_read_b128 v[108:111], v161 offset:96
    v_rcp_f32 v36, v36
    v_rcp_f32 v37, v37
    v_rcp_f32 v38, v38
    v_rcp_f32 v39, v39
    v_rcp_f32 v40, v40
    v_rcp_f32 v41, v41
    v_rcp_f32 v42, v42
    v_rcp_f32 v43, v43
    v_rcp_f32 v44, v44
    v_rcp_f32 v45, v45
    v_rcp_f32 v46, v46
    v_rcp_f32 v47, v47
    v_pk_mul_f32 v[32:33], v[32:33], v[0:1]
    v_pk_mul_f32 v[34:35], v[34:35], v[2:3]
    v_pk_mul_f32 v[36:37], v[36:37], v[4:5]
    v_pk_mul_f32 v[38:39], v[38:39], v[6:7]
    v_pk_mul_f32 v[40:41], v[40:41], v[8:9]
    v_pk_mul_f32 v[42:43], v[42:43], v[10:11]
    v_pk_mul_f32 v[44:45], v[44:45], v[12:13]
    v_pk_mul_f32 v[46:47], v[46:47], v[14:15]
    s_waitcnt lgkmcnt(0)
    v_mfma_f32_32x32x16_bf16 v[0:15], v[96:99], v[128:131], 0
    v_rcp_f32 v48, v48
    s_cmp_lt_u32 s95, 3
    s_cbranch_scc1 L2_nodma2
    buffer_load_dwordx4 v[148:149], s[40:43], s84 idxen offen offset:0 sc1 lds
    buffer_load_dwordx4 v[150:151], s[40:43], s85 idxen offen offset:1056 sc1 lds
    buffer_load_dwordx4 v[152:153], s[40:43], s86 idxen offen offset:2112 sc1 lds
    buffer_load_dwordx4 v[154:155], s[40:43], s87 idxen offen offset:3168 sc1 lds
L2_nodma2:
    v_rcp_f32 v49, v49
    v_rcp_f32 v50, v50
    v_mfma_f32_32x32x16_bf16 v[0:15], v[100:103], v[132:135], v[0:15]
    v_rcp_f32 v51, v51
    v_rcp_f32 v52, v52
    v_rcp_f32 v53, v53
    v_mfma_f32_32x32x16_bf16 v[0:15], v[144:147], v[136:139], v[0:15]
    v_rcp_f32 v54, v54
    v_rcp_f32 v55, v55
    v_rcp_f32 v56, v56
    v_rcp_f32 v57, v57
    v_smfmac_f32_32x32x32_bf16 v[64:79], v[120:123], v[32:39], v156
    v_rcp_f32 v58, v58
    v_rcp_f32 v59, v59
    v_rcp_f32 v60, v60
    v_rcp_f32 v61, v61
    v_smfmac_f32_32x32x32_bf16 v[64:79], v[124:127], v[40:47], v156
    v_rcp_f32 v62, v62
    v_rcp_f32 v63, v63
    v_pk_mul_f32 v[48:49], v[48:49], v[16:17]
    v_pk_mul_f32 v[50:51], v[50:51], v[18:19]
    s_cmp_gt_u32 s95, s80
    s_cbranch_scc1 L2_prd
    s_setprio 2
    s_cmp_gt_u32 s95, 2
    s_cbranch_scc1 L2_prd
    s_setprio 1
    s_cmp_gt_u32 s95, 1
    s_cbranch_scc1 L2_prd
    s_setprio 0
L2_prd:
    v_pk_mul_f32 v[52:53], v[52:53], v[20:21]
    v_pk_mul_f32 v[54:55], v[54:55], v[22:23]
    v_pk_mul_f32 v[56:57], v[56:57], v[24:25]
    v_pk_mul_f32 v[58:59], v[58:59], v[26:27]
    s_sub_u32 s95, s95, 1
    s_cmp_gt_u32 s95, 1
    v_pk_mul_f32 v[60:61], v[60:61], v[28:29]
    v_pk_mul_f32 v[62:63], v[62:63], v[30:31]
    s_cbranch_scc1 L2_loop
L2_last:
    v_mfma_f32_32x32x16_bf16 v[16:31], v[104:107], v[128:131], 0
    v_exp_f32 v32, v0
    v_exp_f32 v33, v1
    v_exp_f32 v34, v2
    v_mfma_f32_32x32x16_bf16 v[16:31], v[108:111], v[132:135], v[16:31]
    v_exp_f32 v35, v3
    v_exp_f32 v36, v4
    v_exp_f32 v37, v5
    v_mfma_f32_32x32x16_bf16 v[16:31], v[144:147], v[140:143], v[16:31]
    v_exp_f32 v38, v6
    v_exp_f32 v39, v7
    s_cmp_lg_u32 s27, 0
    s_cbranch_scc1 L2_npf1
    v_lshlrev_b32 v160, 4, v164
    s_lshl_b32 s72, s24, 15
    s_add_u32 s78, s24, 0
    s_and_b32 s78, s78, 3
    s_lshl_b32 s82, s78, 6
    s_lshl_b32 s78, s78, 10
    s_add_u32 s78, s78, s72
    s_add_u32 s86, s78, 16384
    buffer_load_dwordx4 v[96:99], v160, s[48:51], s78 offen sc1
    buffer_load_dwordx4 v[128:131], v160, s[48:51], s86 offen sc1
    s_add_u32 s79, s24, 1
    s_and_b32 s79, s79, 3
    s_lshl_b32 s83, s79, 6
    s_lshl_b32 s79, s79, 10
    s_add_u32 s79, s79, s72
    s_add_u32 s87, s79, 16384
    buffer_load_dwordx4 v[100:103], v160, s[48:51], s79 offen sc1
    buffer_load_dwordx4 v[132:135], v160, s[48:51], s87 offen sc1
    s_add_u32 s80, s24, 2
    s_and_b32 s80, s80, 3
    s_lshl_b32 s84, s80, 6
    s_lshl_b32 s80, s80, 10
    s_add_u32 s80, s80, s72
    s_add_u32 s88, s80, 16384
    buffer_load_dwordx4 v[104:107], v160, s[48:51], s80 offen sc1
    buffer_load_dwordx4 v[136:139], v160, s[48:51], s88 offen sc1
    s_add_u32 s81, s24, 3
    s_and_b32 s81, s81, 3
    s_lshl_b32 s85, s81, 6
    s_lshl_b32 s81, s81, 10
    s_add_u32 s81, s81, s72
    s_add_u32 s89, s81, 16384
    buffer_load_dwordx4 v[108:111], v160, s[48:51], s81 offen sc1
    buffer_load_dwordx4 v[140:143], v160, s[48:51], s89 offen sc1
    s_add_u32 s76, s72, 4096
    s_add_u32 s77, s72, 20480
    buffer_load_dwordx4 v[144:147], v160, s[48:51], s76 offen offset:0 sc1
    buffer_load_dwordx4 v[148:151], v160, s[48:51], s76 offen offset:1024 sc1
    buffer_load_dwordx4 v[152:155], v160, s[48:51], s76 offen offset:2048 sc1
    buffer_load_dwordx4 v[116:119], v160, s[48:51], s76 offen offset:3072 sc1
L2_npf1:
    v_exp_f32 v40, v8
    v_exp_f32 v41, v9
    v_smfmac_f32_32x32x32_bf16 v[80:95], v[120:123], v[48:55], v156
    v_exp_f32 v42, v10
    v_exp_f32 v43, v11
    v_exp_f32 v44, v12
    v_exp_f32 v45, v13
    v_smfmac_f32_32x32x32_bf16 v[80:95], v[124:127], v[56:63], v156
    v_exp_f32 v46, v14
    v_exp_f32 v47, v15
    v_exp_f32 v48, v16
    v_exp_f32 v49, v17
    v_mfma_f32_32x32x16_bf16 v[32:47], v[112:115], v[112:115], v[32:47]
    v_exp_f32 v50, v18
    v_exp_f32 v51, v19
    v_exp_f32 v52, v20
    v_exp_f32 v53, v21
    v_med3_i32 v126, v159, v162, v163
    ds_read_b64_tr_b16 v[120:121], v126 offset:0
    ds_read_b64_tr_b16 v[122:123], v126 offset:16
    ds_read_b64_tr_b16 v[124:125], v126 offset:32
    ds_read_b64_tr_b16 v[126:127], v126 offset:48
    v_exp_f32 v54, v22
    v_exp_f32 v55, v23
    v_exp_f32 v56, v24
    v_exp_f32 v57, v25
    v_exp_f32 v58, v26
    v_exp_f32 v59, v27
    v_exp_f32 v60, v28
    v_exp_f32 v61, v29
    v_exp_f32 v62, v30
    v_exp_f32 v63, v31
    v_rcp_f32 v32, v32
    v_rcp_f32 v33, v33
    v_mfma_f32_32x32x16_bf16 v[48:63], v[112:115], v[112:115], v[48:63]
    v_rcp_f32 v34, v34
    v_rcp_f32 v35, v35
    v_rcp_f32 v36, v36
    v_rcp_f32 v37, v37
    v_rcp_f32 v38, v38
    v_rcp_f32 v39, v39
    v_rcp_f32 v40, v40
    v_rcp_f32 v41, v41
    v_rcp_f32 v42, v42
    v_rcp_f32 v43, v43
    v_rcp_f32 v44, v44
    v_rcp_f32 v45, v45
    v_rcp_f32 v46, v46
    v_rcp_f32 v47, v47
    v_pk_mul_f32 v[32:33], v[32:33], v[0:1]
    v_pk_mul_f32 v[34:35], v[34:35], v[2:3]
    v_pk_mul_f32 v[36:37], v[36:37], v[4:5]
    v_pk_mul_f32 v[38:39], v[38:39], v[6:7]
    v_pk_mul_f32 v[40:41], v[40:41], v[8:9]
    v_pk_mul_f32 v[42:43], v[42:43], v[10:11]
    v_pk_mul_f32 v[44:45], v[44:45], v[12:13]
    v_pk_mul_f32 v[46:47], v[46:47], v[14:15]
    s_waitcnt lgkmcnt(0)
    s_cmp_lg_u32 s27, 0
    s_cbranch_scc1 L2_npf2
    buffer_load_dwordx4 v[0:3], v160, s[48:51], s77 offen offset:0 sc1
    buffer_load_dwordx4 v[4:7], v160, s[48:51], s77 offen offset:1024 sc1
    buffer_load_dwordx4 v[8:11], v160, s[48:51], s77 offen offset:2048 sc1
    buffer_load_dwordx4 v[12:15], v160, s[48:51], s77 offen offset:3072 sc1
L2_npf2:
    v_rcp_f32 v48, v48
    v_smfmac_f32_32x32x32_bf16 v[64:79], v[120:123], v[32:39], v156
    v_rcp_f32 v49, v49
    v_rcp_f32 v50, v50
    v_mov_b32 v158, 0
    v_and_b32 v160, 31, v164
    s_lshl_b32 s72, s25, 7
    v_rcp_f32 v51, v51
    s_add_u32 s76, s72, 68352
    v_lshl_add_u32 v161, v160, 1, s76
    v_mov_b64 v[162:163], 0
    v_rcp_f32 v52, v52
    v_smfmac_f32_32x32x32_bf16 v[64:79], v[124:127], v[40:47], v156
    ds_read_b32 v159, v158 offset:54780
    v_lshrrev_b32 v157, 5, v164
    s_mul_i32 s77, s28, 272
    v_rcp_f32 v53, v53
    s_add_u32 s77, s77, s72
    s_add_u32 s77, s77, 101872
    ds_read_u16_d16_hi v162, v161
    v_rcp_f32 v54, v54
    ds_read_u16_d16_hi v163, v161 offset:64
    v_rcp_f32 v55, v55
    v_pk_mul_f32 v[48:49], v[48:49], v[16:17]
    v_pk_mul_f32 v[50:51], v[50:51], v[18:19]
    v_pk_mul_f32 v[52:53], v[52:53], v[20:21]
    v_pk_mul_f32 v[54:55], v[54:55], v[22:23]
    v_rcp_f32 v56, v56
    v_rcp_f32 v57, v57
    v_smfmac_f32_32x32x32_bf16 v[80:95], v[120:123], v[48:55], v156
    v_rcp_f32 v58, v58
    v_rcp_f32 v59, v59
    v_rcp_f32 v60, v60
    v_rcp_f32 v61, v61
    v_rcp_f32 v62, v62
    v_rcp_f32 v63, v63
    s_setprio 3
    v_pk_mul_f32 v[56:57], v[56:57], v[24:25]
    v_pk_mul_f32 v[58:59], v[58:59], v[26:27]
    v_pk_mul_f32 v[60:61], v[60:61], v[28:29]
    v_pk_mul_f32 v[62:63], v[62:63], v[30:31]
    v_lshl_add_u32 v160, v160, 2, s77
    v_subrev_u32 v157, s28, v157
    v_smfmac_f32_32x32x32_bf16 v[80:95], v[124:127], v[56:63], v156
    s_movk_i32 s76, 272
    v_and_b32 v112, 7, v157
    v_mad_u32_u24 v112, v112, s76, v160
    v_add_u32 v113, 2, v157
    v_and_b32 v113, 7, v113
    v_mad_u32_u24 v113, v113, s76, v160
    v_add_u32 v114, 4, v157
    v_and_b32 v114, 7, v114
    v_mad_u32_u24 v114, v114, s76, v160
    v_add_u32 v115, 6, v157
    v_and_b32 v115, 7, v115
    v_mad_u32_u24 v115, v115, s76, v160
    s_and_b32 s56, s60, s62
    s_and_b32 s58, s64, s66
    s_andn2_b32 s58, s58, s56
    s_cmp_lg_u32 s73, 0
    s_cselect_b32 s56, -1, s56
    s_cselect_b32 s58, 0, s58
    s_mov_b32 s76, 1065375697
L2_done:
    s_cmp_lg_u32 s29, 0
    s_cbranch_scc1 L2_slownext
    s_waitcnt lgkmcnt(0)
    v_cmp_gt_u32 vcc, 192, v159
    s_cbranch_vccnz L2_flw
L2_t1:
    v_mul_f32 v64, s76, v64
    v_mul_f32 v68, s76, v68
    v_mul_f32 v72, s76, v72
    v_mul_f32 v76, s76, v76
    v_mul_f32 v80, s76, v80
    v_mul_f32 v84, s76, v84
    v_mul_f32 v88, s76, v88
    v_mul_f32 v92, s76, v92
    v_cvt_pk_bf16_f32 v64, v64, v80
    v_cvt_pk_bf16_f32 v68, v68, v84
    v_cvt_pk_bf16_f32 v72, v72, v88
    v_cvt_pk_bf16_f32 v76, v76, v92
    s_bfe_i32 exec_lo, s56, 65536
    s_bfe_i32 exec_hi, s56, 65537
    ds_write_b32 v112, v64
    s_bfe_i32 exec_lo, s56, 65538
    s_bfe_i32 exec_hi, s56, 65539
    ds_write_b32 v113, v68
    s_bfe_i32 exec_lo, s56, 65552
    s_bfe_i32 exec_hi, s56, 65553
    ds_write_b32 v114, v72
    s_bfe_i32 exec_lo, s56, 65554
    s_bfe_i32 exec_hi, s56, 65555
    ds_write_b32 v115, v76
    s_bfe_i32 exec_lo, s58, 65536
    s_bfe_i32 exec_hi, s58, 65537
    ds_pk_add_bf16 v112, v64
    s_bfe_i32 exec_lo, s58, 65538
    s_bfe_i32 exec_hi, s58, 65539
    ds_pk_add_bf16 v113, v68
    s_bfe_i32 exec_lo, s58, 65552
    s_bfe_i32 exec_hi, s58, 65553
    ds_pk_add_bf16 v114, v72
    s_bfe_i32 exec_lo, s58, 65554
    s_bfe_i32 exec_hi, s58, 65555
    ds_pk_add_bf16 v115, v76
    s_mov_b64 exec, 1
    ds_add_u32 v158, v165 offset:54780
    s_mov_b64 exec, -1
    s_cmp_lg_u32 s27, 0
    s_setprio 0
    s_cbranch_scc1 L2_kp
    v_and_b32 v120, 15, v164
    v_lshrrev_b32 v121, 4, v164
    v_xor_b32 v122, v120, v121
    v_lshl_add_u32 v122, v120, 4, v122
    s_mov_b32 s76, 133632
    v_lshl_add_u32 v122, v122, 4, s76
    v_xor_b32 v123, s82, v122
    ds_read_b128 v[16:19], v123 offset:0
    ds_read_b128 v[32:35], v123 offset:4096
    ds_read_b128 v[48:51], v123 offset:8192
    v_xor_b32 v123, s83, v122
    ds_read_b128 v[20:23], v123 offset:0
    ds_read_b128 v[36:39], v123 offset:4096
    ds_read_b128 v[52:55], v123 offset:8192
    v_xor_b32 v123, s84, v122
    ds_read_b128 v[24:27], v123 offset:0
    ds_read_b128 v[40:43], v123 offset:4096
    ds_read_b128 v[56:59], v123 offset:8192
    v_xor_b32 v123, s85, v122
    ds_read_b128 v[28:31], v123 offset:0
    ds_read_b128 v[44:47], v123 offset:4096
    ds_read_b128 v[60:63], v123 offset:8192
L2_kp:
    v_mul_f32 v65, v65, v162
    v_pk_mul_f32 v[66:67], v[66:67], v[162:163] op_sel_hi:[1,0]
    v_fmac_f32 v65, v81, v163
    v_pk_fma_f32 v[66:67], v[82:83], v[162:163], v[66:67] op_sel:[0,1,0]
    v_mul_f32 v69, v69, v162
    v_pk_mul_f32 v[70:71], v[70:71], v[162:163] op_sel_hi:[1,0]
    v_fmac_f32 v69, v85, v163
    v_pk_fma_f32 v[70:71], v[86:87], v[162:163], v[70:71] op_sel:[0,1,0]
    v_mul_f32 v73, v73, v162
    v_pk_mul_f32 v[74:75], v[74:75], v[162:163] op_sel_hi:[1,0]
    v_fmac_f32 v73, v89, v163
    v_pk_fma_f32 v[74:75], v[90:91], v[162:163], v[74:75] op_sel:[0,1,0]
    v_mul_f32 v77, v77, v162
    v_pk_mul_f32 v[78:79], v[78:79], v[162:163] op_sel_hi:[1,0]
    v_fmac_f32 v77, v93, v163
    v_pk_fma_f32 v[78:79], v[94:95], v[162:163], v[78:79] op_sel:[0,1,0]
    v_bfe_u32 v157, v164, 3, 1
    v_lshrrev_b32 v159, 4, v164
    v_bfrev_b32 v159, v159
    v_lshrrev_b32 v159, 30, v159
    v_lshl_add_u32 v157, v157, 2, v159
    v_permlane16_swap_b32 v65, v69
    v_permlane16_swap_b32 v66, v70
    v_permlane16_swap_b32 v67, v71
    v_permlane16_swap_b32 v73, v77
    v_permlane16_swap_b32 v74, v78
    v_permlane16_swap_b32 v75, v79
    s_lshl_b32 s76, s24, 7
    s_add_u32 s76, s76, 131968
    v_lshl_add_u32 v159, v157, 4, s76
    v_subrev_u32 v157, s28, v157
    v_add_f32 v65, v65, v69
    v_pk_add_f32 v[66:67], v[66:67], v[70:71]
    v_add_f32 v73, v73, v77
    v_pk_add_f32 v[74:75], v[74:75], v[78:79]
    v_and_b32 v157, 7, v157
    v_add_u32 v64, s28, v157
    v_add_f32_dpp v65, v65, v65 row_ror:8 row_mask:0xf bank_mask:0x3
    v_add_f32_dpp v66, v66, v66 row_ror:8 row_mask:0xf bank_mask:0x3
    v_add_f32_dpp v67, v67, v67 row_ror:8 row_mask:0xf bank_mask:0x3
    v_add_f32_dpp v65, v73, v73 row_ror:8 row_mask:0xf bank_mask:0xc
    v_add_f32_dpp v66, v74, v74 row_ror:8 row_mask:0xf bank_mask:0xc
    v_add_f32_dpp v67, v75, v75 row_ror:8 row_mask:0xf bank_mask:0xc
    v_add_f32_dpp v65, v65, v65 row_half_mirror row_mask:0xf bank_mask:0xf
    v_add_f32_dpp v66, v66, v66 row_half_mirror row_mask:0xf bank_mask:0xf
    v_add_f32_dpp v67, v67, v67 row_half_mirror row_mask:0xf bank_mask:0xf
    v_add_f32_dpp v65, v65, v65 quad_perm:[1,0,3,2] row_mask:0xf bank_mask:0xf
    v_add_f32_dpp v66, v66, v66 quad_perm:[1,0,3,2] row_mask:0xf bank_mask:0xf
    v_add_f32_dpp v67, v67, v67 quad_perm:[1,0,3,2] row_mask:0xf bank_mask:0xf
    v_add_f32_dpp v65, v65, v65 quad_perm:[2,3,0,1] row_mask:0xf bank_mask:0xf
    v_add_f32_dpp v66, v66, v66 quad_perm:[2,3,0,1] row_mask:0xf bank_mask:0xf
    v_add_f32_dpp v67, v67, v67 quad_perm:[2,3,0,1] row_mask:0xf bank_mask:0xf
    s_mov_b32 exec_lo, 0x01010101
    s_mov_b32 exec_hi, 0x01010101
    ds_write_b128 v159, v[64:67]
    s_mov_b64 exec, 1
    ds_add_rtn_u32 v157, v158, v165 offset:54760
    s_mov_b64 exec, -1
    s_cmp_lg_u32 s27, 0
    s_cbranch_scc1 L2_other0
    s_waitcnt vmcnt(8) lgkmcnt(2)
    v_mfma_f32_16x16x32_bf16 v[68:71], v[96:99], v[16:19], 0
    v_mfma_f32_16x16x32_bf16 v[72:75], v[128:131], v[16:19], 0
    v_mfma_f32_16x16x32_bf16 v[76:79], v[96:99], v[32:35], 0
    v_mfma_f32_16x16x32_bf16 v[80:83], v[128:131], v[32:35], 0
    v_mfma_f32_16x16x32_bf16 v[84:87], v[96:99], v[48:51], 0
    v_mfma_f32_16x16x32_bf16 v[88:91], v[128:131], v[48:51], 0
    v_lshlrev_b32 v121, 4, v121
    v_lshl_add_u32 v124, v120, 8, v121
    v_add_u32 v125, 4096, v124
    v_add_u32 v126, 8192, v124
    v_mfma_f32_16x16x32_bf16 v[68:71], v[100:103], v[20:23], v[68:71]
    v_mfma_f32_16x16x32_bf16 v[72:75], v[132:135], v[20:23], v[72:75]
    v_mfma_f32_16x16x32_bf16 v[76:79], v[100:103], v[36:39], v[76:79]
    v_mfma_f32_16x16x32_bf16 v[80:83], v[132:135], v[36:39], v[80:83]
    v_mfma_f32_16x16x32_bf16 v[84:87], v[100:103], v[52:55], v[84:87]
    v_mfma_f32_16x16x32_bf16 v[88:91], v[132:135], v[52:55], v[88:91]
    v_mul_u32_u24 v120, 272, v120
    s_mov_b32 s76, 102144
    v_add3_u32 v127, s76, v120, v121
    s_add_u32 s60, s20, s71
    s_addc_u32 s61, s21, 0
    s_mov_b32 s62, s54
    s_mov_b32 s63, 0x00020000
    v_mfma_f32_16x16x32_bf16 v[68:71], v[104:107], v[24:27], v[68:71]
    v_mfma_f32_16x16x32_bf16 v[72:75], v[136:139], v[24:27], v[72:75]
    v_mfma_f32_16x16x32_bf16 v[76:79], v[104:107], v[40:43], v[76:79]
    v_mfma_f32_16x16x32_bf16 v[80:83], v[136:139], v[40:43], v[80:83]
    v_mfma_f32_16x16x32_bf16 v[84:87], v[104:107], v[56:59], v[84:87]
    v_mfma_f32_16x16x32_bf16 v[88:91], v[136:139], v[56:59], v[88:91]
    v_mfma_f32_16x16x32_bf16 v[68:71], v[108:111], v[28:31], v[68:71]
    v_mfma_f32_16x16x32_bf16 v[72:75], v[140:143], v[28:31], v[72:75]
    v_mfma_f32_16x16x32_bf16 v[76:79], v[108:111], v[44:47], v[76:79]
    v_mfma_f32_16x16x32_bf16 v[80:83], v[140:143], v[44:47], v[80:83]
    v_mfma_f32_16x16x32_bf16 v[84:87], v[108:111], v[60:63], v[84:87]
    v_mfma_f32_16x16x32_bf16 v[88:91], v[140:143], v[60:63], v[88:91]
    s_mov_b32 s78, 3216550459
    s_mov_b32 s79, 3216550459
    s_mov_b32 s80, 3207688728
    s_mov_b32 s81, 3207688728
    v_lshlrev_b32 v20, 16, v16
    v_and_b32 v21, 0xffff0000, v16
    v_lshlrev_b32 v22, 16, v17
    v_and_b32 v23, 0xffff0000, v17
    v_lshlrev_b32 v24, 16, v18
    v_and_b32 v25, 0xffff0000, v18
    v_lshlrev_b32 v26, 16, v19
    v_and_b32 v27, 0xffff0000, v19
    v_lshlrev_b32 v36, 16, v32
    v_and_b32 v37, 0xffff0000, v32
    v_lshlrev_b32 v38, 16, v33
    v_and_b32 v39, 0xffff0000, v33
    v_lshlrev_b32 v40, 16, v34
    v_and_b32 v41, 0xffff0000, v34
    v_lshlrev_b32 v42, 16, v35
    v_and_b32 v43, 0xffff0000, v35
    v_lshlrev_b32 v52, 16, v48
    v_and_b32 v53, 0xffff0000, v48
    v_lshlrev_b32 v54, 16, v49
    v_and_b32 v55, 0xffff0000, v49
    v_lshlrev_b32 v56, 16, v50
    v_and_b32 v57, 0xffff0000, v50
    v_lshlrev_b32 v58, 16, v51
    v_and_b32 v59, 0xffff0000, v51
    v_pk_mul_f32 v[68:69], v[68:69], s[78:79]
    v_pk_mul_f32 v[70:71], v[70:71], s[78:79]
    v_pk_mul_f32 v[72:73], v[72:73], s[78:79]
    v_pk_mul_f32 v[74:75], v[74:75], s[78:79]
    v_pk_mul_f32 v[76:77], v[76:77], s[78:79]
    v_pk_mul_f32 v[78:79], v[78:79], s[78:79]
    v_pk_mul_f32 v[80:81], v[80:81], s[78:79]
    v_pk_mul_f32 v[82:83], v[82:83], s[78:79]
    v_pk_mul_f32 v[84:85], v[84:85], s[78:79]
    v_pk_mul_f32 v[86:87], v[86:87], s[78:79]
    v_pk_mul_f32 v[88:89], v[88:89], s[78:79]
    v_pk_mul_f32 v[90:91], v[90:91], s[78:79]
    s_waitcnt vmcnt(0)
    s_setprio 3
L2_gsp:
    ds_read_b32 v159, v158 offset:54780
    s_waitcnt lgkmcnt(0)
    v_cmp_ne_u32 vcc, 384, v159
    s_cbranch_vccz L2_gspd
    s_sleep 1
    s_branch L2_gsp
L2_gspd:
    ds_read_b128 v[96:99], v127 offset:0
    ds_read_b128 v[100:103], v127 offset:64
    ds_read_b128 v[104:107], v127 offset:128
    ds_read_b128 v[108:111], v127 offset:192
    ds_read_b128 v[128:131], v127 offset:4352
    ds_read_b128 v[132:135], v127 offset:4416
    ds_read_b128 v[136:139], v127 offset:4480
    ds_read_b128 v[140:143], v127 offset:4544
    ds_read_b128 v[28:31], v127 offset:8704
    ds_read_b128 v[44:47], v127 offset:8768
    ds_read_b128 v[60:63], v127 offset:8832
    ds_read_b128 v[92:95], v127 offset:8896
    s_waitcnt lgkmcnt(11)
    v_mfma_f32_16x16x32_bf16 v[68:71], v[144:147], v[96:99], v[68:71]
    v_mfma_f32_16x16x32_bf16 v[72:75], v[0:3], v[96:99], v[72:75]
    s_waitcnt lgkmcnt(10)
    v_mfma_f32_16x16x32_bf16 v[68:71], v[148:151], v[100:103], v[68:71]
    v_mfma_f32_16x16x32_bf16 v[72:75], v[4:7], v[100:103], v[72:75]
    s_waitcnt lgkmcnt(9)
    v_mfma_f32_16x16x32_bf16 v[68:71], v[152:155], v[104:107], v[68:71]
    v_mfma_f32_16x16x32_bf16 v[72:75], v[8:11], v[104:107], v[72:75]
    s_waitcnt lgkmcnt(8)
    v_mfma_f32_16x16x32_bf16 v[68:71], v[116:119], v[108:111], v[68:71]
    v_mfma_f32_16x16x32_bf16 v[72:75], v[12:15], v[108:111], v[72:75]
    s_waitcnt lgkmcnt(7)
    v_mfma_f32_16x16x32_bf16 v[76:79], v[144:147], v[128:131], v[76:79]
    v_mfma_f32_16x16x32_bf16 v[80:83], v[0:3], v[128:131], v[80:83]
    s_waitcnt lgkmcnt(6)
    v_mfma_f32_16x16x32_bf16 v[76:79], v[148:151], v[132:135], v[76:79]
    v_mfma_f32_16x16x32_bf16 v[80:83], v[4:7], v[132:135], v[80:83]
    s_waitcnt lgkmcnt(5)
    v_mfma_f32_16x16x32_bf16 v[76:79], v[152:155], v[136:139], v[76:79]
    v_mfma_f32_16x16x32_bf16 v[80:83], v[8:11], v[136:139], v[80:83]
    s_waitcnt lgkmcnt(4)
    v_mfma_f32_16x16x32_bf16 v[76:79], v[116:119], v[140:143], v[76:79]
    v_mfma_f32_16x16x32_bf16 v[80:83], v[12:15], v[140:143], v[80:83]
    v_exp_f32 v96, v68
    v_exp_f32 v97, v69
    s_waitcnt lgkmcnt(3)
    v_mfma_f32_16x16x32_bf16 v[84:87], v[144:147], v[28:31], v[84:87]
    v_mfma_f32_16x16x32_bf16 v[88:91], v[0:3], v[28:31], v[88:91]
    v_exp_f32 v98, v70
    v_exp_f32 v99, v71
    s_waitcnt lgkmcnt(2)
    v_mfma_f32_16x16x32_bf16 v[84:87], v[148:151], v[44:47], v[84:87]
    v_mfma_f32_16x16x32_bf16 v[88:91], v[4:7], v[44:47], v[88:91]
    v_exp_f32 v100, v72
    v_exp_f32 v101, v73
    s_waitcnt lgkmcnt(1)
    v_mfma_f32_16x16x32_bf16 v[84:87], v[152:155], v[60:63], v[84:87]
    v_mfma_f32_16x16x32_bf16 v[88:91], v[8:11], v[60:63], v[88:91]
    v_exp_f32 v102, v74
    v_exp_f32 v103, v75
    s_waitcnt lgkmcnt(0)
    v_mfma_f32_16x16x32_bf16 v[84:87], v[116:119], v[92:95], v[84:87]
    v_mfma_f32_16x16x32_bf16 v[88:91], v[12:15], v[92:95], v[88:91]
    v_pk_add_f32 v[96:97], v[96:97], 1.0 op_sel_hi:[1,0]
    v_pk_add_f32 v[98:99], v[98:99], 1.0 op_sel_hi:[1,0]
    v_pk_add_f32 v[100:101], v[100:101], 1.0 op_sel_hi:[1,0]
    v_pk_add_f32 v[102:103], v[102:103], 1.0 op_sel_hi:[1,0]
    v_rcp_f32 v96, v96
    v_rcp_f32 v97, v97
    v_rcp_f32 v98, v98
    v_rcp_f32 v99, v99
    v_rcp_f32 v100, v100
    v_rcp_f32 v101, v101
    v_rcp_f32 v102, v102
    v_rcp_f32 v103, v103
    v_pk_mul_f32 v[96:97], v[96:97], v[68:69]
    v_pk_mul_f32 v[98:99], v[98:99], v[70:71]
    v_pk_mul_f32 v[100:101], v[100:101], v[72:73]
    v_pk_mul_f32 v[102:103], v[102:103], v[74:75]
    v_pk_fma_f32 v[96:97], v[96:97], s[80:81], v[20:21]
    v_pk_fma_f32 v[98:99], v[98:99], s[80:81], v[22:23]
    v_pk_fma_f32 v[100:101], v[100:101], s[80:81], v[24:25]
    v_pk_fma_f32 v[102:103], v[102:103], s[80:81], v[26:27]
    v_cvt_pk_bf16_f32 v16, v96, v97
    v_cvt_pk_bf16_f32 v17, v98, v99
    v_cvt_pk_bf16_f32 v18, v100, v101
    v_cvt_pk_bf16_f32 v19, v102, v103
    buffer_store_dwordx4 v[16:19], v124, s[60:63], s82 offen
    v_exp_f32 v128, v76
    v_exp_f32 v129, v77
    v_exp_f32 v130, v78
    v_exp_f32 v131, v79
    v_exp_f32 v132, v80
    v_exp_f32 v133, v81
    v_exp_f32 v134, v82
    v_exp_f32 v135, v83
    v_pk_add_f32 v[128:129], v[128:129], 1.0 op_sel_hi:[1,0]
    v_pk_add_f32 v[130:131], v[130:131], 1.0 op_sel_hi:[1,0]
    v_pk_add_f32 v[132:133], v[132:133], 1.0 op_sel_hi:[1,0]
    v_pk_add_f32 v[134:135], v[134:135], 1.0 op_sel_hi:[1,0]
    v_rcp_f32 v128, v128
    v_rcp_f32 v129, v129
    v_rcp_f32 v130, v130
    v_rcp_f32 v131, v131
    v_rcp_f32 v132, v132
    v_rcp_f32 v133, v133
    v_rcp_f32 v134, v134
    v_rcp_f32 v135, v135
    v_pk_mul_f32 v[128:129], v[128:129], v[76:77]
    v_pk_mul_f32 v[130:131], v[130:131], v[78:79]
    v_pk_mul_f32 v[132:133], v[132:133], v[80:81]
    v_pk_mul_f32 v[134:135], v[134:135], v[82:83]
    v_pk_fma_f32 v[128:129], v[128:129], s[80:81], v[36:37]
    v_pk_fma_f32 v[130:131], v[130:131], s[80:81], v[38:39]
    v_pk_fma_f32 v[132:133], v[132:133], s[80:81], v[40:41]
    v_pk_fma_f32 v[134:135], v[134:135], s[80:81], v[42:43]
    v_cvt_pk_bf16_f32 v32, v128, v129
    v_cvt_pk_bf16_f32 v33, v130, v131
    v_cvt_pk_bf16_f32 v34, v132, v133
    v_cvt_pk_bf16_f32 v35, v134, v135
    buffer_store_dwordx4 v[32:35], v125, s[60:63], s82 offen
    v_exp_f32 v28, v84
    v_exp_f32 v29, v85
    v_exp_f32 v30, v86
    v_exp_f32 v31, v87
    v_exp_f32 v44, v88
    v_exp_f32 v45, v89
    v_exp_f32 v46, v90
    v_exp_f32 v47, v91
    v_pk_add_f32 v[28:29], v[28:29], 1.0 op_sel_hi:[1,0]
    v_pk_add_f32 v[30:31], v[30:31], 1.0 op_sel_hi:[1,0]
    v_pk_add_f32 v[44:45], v[44:45], 1.0 op_sel_hi:[1,0]
    v_pk_add_f32 v[46:47], v[46:47], 1.0 op_sel_hi:[1,0]
    v_rcp_f32 v28, v28
    v_rcp_f32 v29, v29
    v_rcp_f32 v30, v30
    v_rcp_f32 v31, v31
    v_rcp_f32 v44, v44
    v_rcp_f32 v45, v45
    v_rcp_f32 v46, v46
    v_rcp_f32 v47, v47
    v_pk_mul_f32 v[28:29], v[28:29], v[84:85]
    v_pk_mul_f32 v[30:31], v[30:31], v[86:87]
    v_pk_mul_f32 v[44:45], v[44:45], v[88:89]
    v_pk_mul_f32 v[46:47], v[46:47], v[90:91]
    v_pk_fma_f32 v[28:29], v[28:29], s[80:81], v[52:53]
    v_pk_fma_f32 v[30:31], v[30:31], s[80:81], v[54:55]
    v_pk_fma_f32 v[44:45], v[44:45], s[80:81], v[56:57]
    v_pk_fma_f32 v[46:47], v[46:47], s[80:81], v[58:59]
    v_cvt_pk_bf16_f32 v48, v28, v29
    v_cvt_pk_bf16_f32 v49, v30, v31
    v_cvt_pk_bf16_f32 v50, v44, v45
    v_cvt_pk_bf16_f32 v51, v46, v47
    buffer_store_dwordx4 v[48:51], v126, s[60:63], s82 offen
L2_other0:
    s_waitcnt lgkmcnt(0)
    v_readfirstlane_b32 s56, v157
L2_other:
    s_mov_b64 exec, -1
    s_cmp_lg_u32 s56, 176
    s_cbranch_scc1 L2_exit
    v_add_u32 v1, 1, v164
    v_and_b32 v4, 7, v1
    v_lshlrev_b32 v4, 4, v4
    v_add_u32 v4, 131968, v4
    s_mul_i32 s72, s3, 6
    v_mul_u32_u24 v2, 6, v164
    v_lshlrev_b32 v3, 4, v164
    ds_read_b96 v[12:14], v3 offset:54784
    ds_read_b128 v[20:23], v4 offset:0
    ds_read_b128 v[24:27], v4 offset:128
    ds_read_b128 v[28:31], v4 offset:256
    ds_read_b128 v[32:35], v4 offset:384
    ds_read_b128 v[36:39], v4 offset:512
    ds_read_b128 v[40:43], v4 offset:640
    ds_read_b128 v[44:47], v4 offset:768
    ds_read_b128 v[48:51], v4 offset:896
    ds_read_b128 v[52:55], v4 offset:1024
    ds_read_b128 v[56:59], v4 offset:1152
    ds_read_b128 v[60:63], v4 offset:1280
    ds_read_b128 v[64:67], v4 offset:1408
    s_add_u32 s73, s72, 2560000
    s_add_u32 s60, s20, s73
    s_addc_u32 s61, s21, 0
    s_mul_i32 s62, s70, 6
    s_mov_b32 s63, 0x00020000
    v_mov_b64 v[16:17], 0
    v_mov_b64 v[18:19], 0
    s_mov_b32 s76, 3207719894
    s_waitcnt lgkmcnt(11)
    v_cmp_eq_u32 vcc, v20, v1
    s_mov_b64 exec, vcc
    v_add_f32 v17, v17, v21
    v_pk_add_f32 v[18:19], v[18:19], v[22:23]
    s_mov_b64 exec, -1
    s_waitcnt lgkmcnt(10)
    v_cmp_eq_u32 vcc, v24, v1
    s_mov_b64 exec, vcc
    v_add_f32 v17, v17, v25
    v_pk_add_f32 v[18:19], v[18:19], v[26:27]
    s_mov_b64 exec, -1
    s_waitcnt lgkmcnt(9)
    v_cmp_eq_u32 vcc, v28, v1
    s_mov_b64 exec, vcc
    v_add_f32 v17, v17, v29
    v_pk_add_f32 v[18:19], v[18:19], v[30:31]
    s_mov_b64 exec, -1
    s_waitcnt lgkmcnt(8)
    v_cmp_eq_u32 vcc, v32, v1
    s_mov_b64 exec, vcc
    v_add_f32 v17, v17, v33
    v_pk_add_f32 v[18:19], v[18:19], v[34:35]
    s_mov_b64 exec, -1
    s_waitcnt lgkmcnt(7)
    v_cmp_eq_u32 vcc, v36, v1
    s_mov_b64 exec, vcc
    v_add_f32 v17, v17, v37
    v_pk_add_f32 v[18:19], v[18:19], v[38:39]
    s_mov_b64 exec, -1
    s_waitcnt lgkmcnt(6)
    v_cmp_eq_u32 vcc, v40, v1
    s_mov_b64 exec, vcc
    v_add_f32 v17, v17, v41
    v_pk_add_f32 v[18:19], v[18:19], v[42:43]
    s_mov_b64 exec, -1
    s_waitcnt lgkmcnt(5)
    v_cmp_eq_u32 vcc, v44, v1
    s_mov_b64 exec, vcc
    v_add_f32 v17, v17, v45
    v_pk_add_f32 v[18:19], v[18:19], v[46:47]
    s_mov_b64 exec, -1
    s_waitcnt lgkmcnt(4)
    v_cmp_eq_u32 vcc, v48, v1
    s_mov_b64 exec, vcc
    v_add_f32 v17, v17, v49
    v_pk_add_f32 v[18:19], v[18:19], v[50:51]
    s_mov_b64 exec, -1
    s_waitcnt lgkmcnt(3)
    v_cmp_eq_u32 vcc, v52, v1
    s_mov_b64 exec, vcc
    v_add_f32 v17, v17, v53
    v_pk_add_f32 v[18:19], v[18:19], v[54:55]
    s_mov_b64 exec, -1
    s_waitcnt lgkmcnt(2)
    v_cmp_eq_u32 vcc, v56, v1
    s_mov_b64 exec, vcc
    v_add_f32 v17, v17, v57
    v_pk_add_f32 v[18:19], v[18:19], v[58:59]
    s_mov_b64 exec, -1
    s_waitcnt lgkmcnt(1)
    v_cmp_eq_u32 vcc, v60, v1
    s_mov_b64 exec, vcc
    v_add_f32 v17, v17, v61
    v_pk_add_f32 v[18:19], v[18:19], v[62:63]
    s_mov_b64 exec, -1
    s_waitcnt lgkmcnt(0)
    v_cmp_eq_u32 vcc, v64, v1
    s_mov_b64 exec, vcc
    v_add_f32 v17, v17, v65
    v_pk_add_f32 v[18:19], v[18:19], v[66:67]
    s_mov_b64 exec, -1
    v_fma_f32 v12, v17, s76, v12
    v_fma_f32 v13, v18, s76, v13
    v_fma_f32 v14, v19, s76, v14
    v_cvt_pk_bf16_f32 v12, v12, v13
    v_cvt_pk_bf16_f32 v14, v14, v14
    buffer_store_short v12, v2, s[60:63], 0 offen
    buffer_store_short_d16_hi v12, v2, s[60:63], 0 offen offset:2
    buffer_store_short v14, v2, s[60:63], 0 offen offset:4
L2_exit:
    s_endpgm
L2_secG:
    global_load_dword v51, v31, s[22:23] sc1
    s_waitcnt lgkmcnt(0)
    v_add_u32_dpp v20, v21, v21 row_shr:1 row_mask:0xf bank_mask:0xf bound_ctrl:0
    s_nop 0
    s_mov_b32 s84, 4096
    v_add_u32_dpp v20, v20, v20 row_shr:2 row_mask:0xf bank_mask:0xf bound_ctrl:0
    s_mov_b32 s85, 3040
    s_mov_b32 s86, 1984
    v_add_u32_dpp v20, v20, v20 row_shr:4 row_mask:0xf bank_mask:0xf bound_ctrl:0
    s_mov_b32 s87, 928
    s_mov_b32 s88, 512
    v_add_u32_dpp v20, v20, v20 row_shr:8 row_mask:0xf bank_mask:0xf bound_ctrl:0
    s_lshl_b32 s32, s24, 15
    s_add_u32 s32, s32, 8192
    v_add_u32_dpp v20, v20, v20 row_bcast:15 row_mask:0xa bank_mask:0xf
    s_add_u32 s33, s32, 16384
    s_lshl_b32 s35, s24, 6
    v_add_u32_dpp v20, v20, v20 row_bcast:31 row_mask:0xc bank_mask:0xf
    v_sub_u32 v21, v20, v21
    ds_bpermute_b32 v10, v10, v21
    ds_bpermute_b32 v11, v11, v21
    ds_bpermute_b32 v12, v12, v21
    v_readlane_b32 s80, v20, 40
    v_readlane_b32 s81, v20, 16
    v_readlane_b32 s82, v20, 24
    s_cmp_gt_u32 s80, 24576
    s_cbranch_scc1 L2_goslow
    s_waitcnt lgkmcnt(0)
    s_mov_b64 exec, s[60:61]
    v_add_u32 v15, v15, v10
    ds_write_b64 v15, v[96:97]
    s_mov_b64 exec, s[62:63]
    v_add_u32 v16, v16, v11
    ds_write_b64 v16, v[98:99]
    s_mov_b64 exec, s[14:15]
    v_add_u32 v17, v17, v12
    ds_write_b64 v17, v[100:101]
    s_mov_b64 exec, -1
    s_cmp_lg_u32 s90, 0
    s_cbranch_scc1 L2_ov2G
L2_ov2_doneG:
    ds_read_b128 v[116:119], v48 offset:55552
    ds_read_b128 v[40:43], v48 offset:59648
    ds_read_b128 v[136:139], v48 offset:63744
    v_xor_b32 v49, 64, v48
    ds_read_b128 v[120:123], v49 offset:55552
    ds_read_b128 v[52:55], v49 offset:59648
    ds_read_b128 v[140:143], v49 offset:63744
    v_xor_b32 v49, 128, v48
    ds_read_b128 v[32:35], v49 offset:55552
    ds_read_b128 v[56:59], v49 offset:59648
    ds_read_b128 v[152:155], v49 offset:63744
    v_xor_b32 v49, 192, v48
    ds_read_b128 v[36:39], v49 offset:55552
    ds_read_b128 v[60:63], v49 offset:59648
    ds_read_b128 v[148:151], v49 offset:63744
    s_add_u32 s83, s80, 1023
    s_lshr_b32 s83, s83, 10
    s_lshl_b32 s83, s83, 9
    s_add_u32 s79, s80, 511
    s_andn2_b32 s79, s79, 511
    s_cmp_eq_u32 s26, 0
    s_cselect_b32 s76, 0, s83
    s_cselect_b32 s77, s83, s79
    v_cmp_ge_u32 vcc, s76, v20
    s_min_u32 s78, s83, s80
    s_cmp_lt_u32 s82, s78
    s_cselect_b32 s73, 1, s29
    s_cmp_gt_u32 s81, s83
    s_cselect_b32 s73, 1, s73
    s_min_u32 s78, s77, s80
    s_bcnt1_i32_b64 s28, vcc
    s_add_u32 s79, s28, 7
    s_cmp_lg_u32 s73, 0
    v_readlane_b32 s81, v20, s79
    s_cbranch_scc1 L2_fixedG
    s_andn2_b32 s82, s81, 511
    s_min_u32 s82, s82, s77
    v_cmp_ge_u32 vcc, s82, v20
    s_cmp_eq_u32 s27, 1
    s_cselect_b32 s94, s76, s82
    s_bcnt1_i32_b64 s83, vcc
    s_add_u32 s79, s83, 7
    v_readlane_b32 s64, v20, s79
    s_andn2_b32 s65, s64, 511
    s_min_u32 s65, s65, s77
    v_cmp_ge_u32 vcc, s65, v20
    s_mov_b32 s66, s82
    s_mov_b32 s67, s65
    s_bcnt1_i32_b64 s68, vcc
    s_add_u32 s79, s68, 7
    v_readlane_b32 s69, v20, s79
    s_cmp_lt_u32 s69, s78
    s_cbranch_scc1 L2_chfixG
L2_chselG:
    s_cmp_eq_u32 s27, 1
    s_cselect_b32 s95, s66, s67
    s_cselect_b32 s28, s28, s83
    s_cmp_eq_u32 s27, 0
    s_cselect_b32 s94, s65, s94
    s_cselect_b32 s95, s77, s95
    s_cselect_b32 s28, s68, s28
L2_chdoneG:
    s_lshl_b32 s79, s28, 2
    s_movk_i32 s81, -32
    v_add_u32 v23, s79, v163
    v_and_or_b32 v23, v23, s81, v162
    v_min_u32 v23, 164, v23
    ds_bpermute_b32 v162, v23, v21
    ds_bpermute_b32 v163, v23, v20
    v_add_u32 v160, s94, v160
    s_mov_b32 s82, 102144
    s_mov_b32 s83, 0x0000bf80
    s_mov_b32 s56, 0xbf800000
    s_waitcnt vmcnt(0)
    v_cmp_eq_u32 vcc, 0, v51
    s_cbranch_vccnz L2_poll2G
L2_poll2dG:
    buffer_load_dwordx4 v[64:67], v30, s[48:51], s32 offen offset:0 sc1
    buffer_load_dwordx4 v[80:83], v30, s[48:51], s33 offen offset:0 sc1
    buffer_load_dwordx4 v[68:71], v30, s[48:51], s32 offen offset:1024 sc1
    buffer_load_dwordx4 v[84:87], v30, s[48:51], s33 offen offset:1024 sc1
    buffer_load_dwordx4 v[72:75], v30, s[48:51], s32 offen offset:2048 sc1
    buffer_load_dwordx4 v[88:91], v30, s[48:51], s33 offen offset:2048 sc1
    buffer_load_dwordx4 v[76:79], v30, s[48:51], s32 offen offset:3072 sc1
    buffer_load_dwordx4 v[92:95], v30, s[48:51], s33 offen offset:3072 sc1
    s_mov_b32 m0, s31
    s_waitcnt lgkmcnt(0)
    s_barrier
    ds_read_b64 v[2:3], v167
    ds_read_b64 v[4:5], v28
    s_min_u32 s58, s95, s80
    s_sub_u32 s95, s95, s94
    s_lshr_b32 s95, s95, 9
    s_lshl_b32 s79, s28, 8
    s_add_u32 s79, s79, 55296
    s_sub_u32 s78, s79, 1024
    v_add_u32 v16, s79, v144
    v_add_u32 v17, s78, v144
    v_add_u32 v158, s94, v158
    v_lshlrev_b32 v22, 5, v23
    v_and_or_b32 v16, v16, v145, v146
    v_and_or_b32 v17, v17, v145, v147
    v_add3_u32 v159, v159, v22, s94
    v_xor_b32 v18, 64, v16
    v_xor_b32 v19, 64, v17
    v_add_u32 v29, 102144, v167
    v_xor_b32 v50, s35, v50
    s_mov_b32 s75, s95
    s_waitcnt lgkmcnt(1)
    v_mad_u32_u24 v6, v2, 6, s82
    v_bfe_u32 v26, v3, 2, 6
    v_and_b32 v6, -4, v6
    v_lshlrev_b32 v7, 4, v26
    ds_read2_b32 v[44:45], v6 offset0:0 offset1:1
    ds_read_b96 v[10:12], v7 offset:54768
    v_lshlrev_b32 v13, 4, v2
    s_cmp_ge_u32 s72, s80
    s_waitcnt lgkmcnt(2)
    s_cbranch_scc1 L2_nod1G
    v_mad_u32_u24 v8, v4, 6, s82
    v_bfe_u32 v27, v5, 2, 6
    v_and_b32 v8, -4, v8
    v_lshlrev_b32 v9, 4, v27
    ds_read2_b32 v[24:25], v8 offset0:0 offset1:1
    ds_read_b96 v[46:48], v9 offset:54768
    v_lshlrev_b32 v14, 4, v4
L2_nod1G:
    s_movk_i32 s78, -56
    s_movk_i32 s79, 72
    v_cmp_le_u32 s[60:61], s94, v162
    v_cmp_ge_u32 s[62:63], s58, v163
    v_cmp_gt_u32 s[64:65], s58, v162
    v_cmp_lt_u32 s[66:67], s94, v163
    v_add_u32 v163, -16, v163
    v_and_b32 v162, 0xffffffc0, v162
    v_and_b32 v163, 0xffffffc0, v163
    v_add3_u32 v162, v162, v22, s78
    v_add3_u32 v163, v163, v22, s79
    v_cmp_ne_u32 s[76:77], 0, v3
    v_bfe_u32 v6, v3, 1, 4
    v_add_u32 v6, v6, v167
    v_lshl_add_u32 v7, v26, 7, v167
    s_waitcnt lgkmcnt(0)
    v_alignbit_b32 v44, v45, v44, v13
    v_lshrrev_b32 v45, v13, v45
    v_dot2_f32_bf16 v10, v44, s83, v10
    v_dot2_f32_bf16 v11, v44, s56, v11
    v_dot2_f32_bf16 v12, v45, s83, v12
    s_nop 0
    v_cvt_pk_bf16_f32 v2, 1.0, v10
    s_nop 0
    v_cvt_pk_bf16_f32 v3, v11, v12
    v_dot2_f32_bf16 v10, v2, v2, -1.0
    v_dot2_f32_bf16 v10, v3, v3, v10
    s_mov_b64 exec, s[76:77]
    ds_write_b16 v6, v166 offset:29952
    ds_write_b64 v7, v[2:3] offset:8
    v_mul_f32 v10, 3216550459, v10
    v_cvt_pk_bf16_f32 v10, v10, v10
    ds_write_b16 v167, v10 offset:4
    s_mov_b64 exec, -1
    s_waitcnt vmcnt(6)
    v_mfma_f32_16x16x32_bf16 v[96:99], v[64:67], v[116:119], 0
    v_mfma_f32_16x16x32_bf16 v[100:103], v[80:83], v[116:119], 0
    v_mfma_f32_16x16x32_bf16 v[104:107], v[64:67], v[40:43], 0
    v_mfma_f32_16x16x32_bf16 v[112:115], v[80:83], v[40:43], 0
    v_mfma_f32_16x16x32_bf16 v[116:119], v[64:67], v[136:139], 0
    v_mfma_f32_16x16x32_bf16 v[124:127], v[80:83], v[136:139], 0
    s_waitcnt vmcnt(4)
    v_mfma_f32_16x16x32_bf16 v[96:99], v[68:71], v[120:123], v[96:99]
    v_mfma_f32_16x16x32_bf16 v[100:103], v[84:87], v[120:123], v[100:103]
    v_mfma_f32_16x16x32_bf16 v[104:107], v[68:71], v[52:55], v[104:107]
    v_mfma_f32_16x16x32_bf16 v[112:115], v[84:87], v[52:55], v[112:115]
    v_mfma_f32_16x16x32_bf16 v[116:119], v[68:71], v[140:143], v[116:119]
    v_mfma_f32_16x16x32_bf16 v[124:127], v[84:87], v[140:143], v[124:127]
    s_cmp_ge_u32 s72, s80
    s_cbranch_scc1 L2_nod2G
    v_cmp_ne_u32 s[78:79], 0, v5
    v_bfe_u32 v8, v5, 1, 4
    v_add_u32 v8, v8, v28
    v_lshl_add_u32 v9, v27, 7, v28
    v_alignbit_b32 v24, v25, v24, v14
    v_lshrrev_b32 v25, v14, v25
    v_dot2_f32_bf16 v46, v24, s83, v46
    v_dot2_f32_bf16 v47, v24, s56, v47
    v_dot2_f32_bf16 v48, v25, s83, v48
    s_nop 0
    v_cvt_pk_bf16_f32 v4, 1.0, v46
    s_nop 0
    v_cvt_pk_bf16_f32 v5, v47, v48
    v_dot2_f32_bf16 v46, v4, v4, -1.0
    v_dot2_f32_bf16 v46, v5, v5, v46
    s_mov_b64 exec, s[78:79]
    ds_write_b16 v8, v166 offset:29952
    ds_write_b64 v9, v[4:5] offset:8
    v_mul_f32 v46, 3216550459, v46
    v_cvt_pk_bf16_f32 v46, v46, v46
    ds_write_b16 v28, v46 offset:4
    s_mov_b64 exec, -1
L2_nod2G:
    s_waitcnt vmcnt(2)
    v_mfma_f32_16x16x32_bf16 v[96:99], v[72:75], v[32:35], v[96:99]
    v_mfma_f32_16x16x32_bf16 v[100:103], v[88:91], v[32:35], v[100:103]
    v_mfma_f32_16x16x32_bf16 v[104:107], v[72:75], v[56:59], v[104:107]
    v_mfma_f32_16x16x32_bf16 v[112:115], v[88:91], v[56:59], v[112:115]
    v_mfma_f32_16x16x32_bf16 v[116:119], v[72:75], v[152:155], v[116:119]
    v_mfma_f32_16x16x32_bf16 v[124:127], v[88:91], v[152:155], v[124:127]
    s_waitcnt vmcnt(0)
    v_mfma_f32_16x16x32_bf16 v[96:99], v[76:79], v[36:39], v[96:99]
    v_mfma_f32_16x16x32_bf16 v[100:103], v[92:95], v[36:39], v[100:103]
    v_mfma_f32_16x16x32_bf16 v[104:107], v[76:79], v[60:63], v[104:107]
    v_mfma_f32_16x16x32_bf16 v[112:115], v[92:95], v[60:63], v[112:115]
    v_mfma_f32_16x16x32_bf16 v[116:119], v[76:79], v[148:151], v[116:119]
    v_mfma_f32_16x16x32_bf16 v[124:127], v[92:95], v[148:151], v[124:127]
    ds_read_b32 v148, v160 offset:0
    ds_read_b32 v150, v160 offset:128
    ds_read_b32 v152, v160 offset:256
    ds_read_b32 v154, v160 offset:384
    v_mov_b32 v149, v157
    v_mov_b32 v151, v157
    v_mov_b32 v153, v157
    v_mov_b32 v155, v157
    s_mov_b32 s76, 3216550459
    s_mov_b32 s77, 3216550459
    s_mov_b32 s57, 0
    v_pk_mul_f32 v[96:97], v[96:97], s[76:77]
    v_pk_mul_f32 v[98:99], v[98:99], s[76:77]
    v_pk_mul_f32 v[100:101], v[100:101], s[76:77]
    v_pk_mul_f32 v[102:103], v[102:103], s[76:77]
    v_cvt_pk_bf16_f32 v32, v96, v97
    v_cvt_pk_bf16_f32 v33, v98, v99
    v_cvt_pk_bf16_f32 v34, v100, v101
    v_cvt_pk_bf16_f32 v35, v102, v103
    ds_write_b128 v50, v[32:35] offset:55552
    v_pk_mul_f32 v[104:105], v[104:105], s[76:77]
    v_pk_mul_f32 v[106:107], v[106:107], s[76:77]
    v_pk_mul_f32 v[112:113], v[112:113], s[76:77]
    v_pk_mul_f32 v[114:115], v[114:115], s[76:77]
    v_cvt_pk_bf16_f32 v36, v104, v105
    v_cvt_pk_bf16_f32 v37, v106, v107
    v_cvt_pk_bf16_f32 v38, v112, v113
    v_cvt_pk_bf16_f32 v39, v114, v115
    ds_write_b128 v50, v[36:39] offset:59648
    v_pk_mul_f32 v[116:117], v[116:117], s[76:77]
    v_pk_mul_f32 v[118:119], v[118:119], s[76:77]
    v_pk_mul_f32 v[124:125], v[124:125], s[76:77]
    v_pk_mul_f32 v[126:127], v[126:127], s[76:77]
    v_cvt_pk_bf16_f32 v40, v116, v117
    v_cvt_pk_bf16_f32 v41, v118, v119
    v_cvt_pk_bf16_f32 v42, v124, v125
    v_cvt_pk_bf16_f32 v43, v126, v127
    ds_write_b128 v50, v[40:43] offset:63744
    s_branch L2_b3
L1_ovf:
    v_mov_b32 v83, 1024
    v_mov_b32 v84, 8
    v_cmp_le_u32 vcc, s86, v76
    s_cbranch_vccz L1_ovf0
    s_mov_b64 exec, vcc
    ds_add_rtn_u32 v76, v83, v84 offset:55552
    v_lshrrev_b32 v82, 16, v8
    v_add_u32 v85, 4, v70
    v_lshl_or_b32 v82, v85, 6, v82
    v_mov_b32 v85, v64
    v_mov_b32 v64, 36992
    s_waitcnt lgkmcnt(0)
    v_cmp_le_u32 vcc, 128, v76
    v_min_u32 v76, 128, v76
    v_add_u32 v76, 93952, v76
    ds_write2_b32 v76, v14, v82 offset0:0 offset1:1
    v_mov_b32 v76, 0
    s_cbranch_vccz L1_ovg0
    s_mov_b64 exec, vcc
    ds_write_b8 v85, v23 offset:57103
L1_ovg0:
    s_mov_b64 exec, -1
L1_ovf0:
    v_cmp_le_u32 vcc, s86, v77
    s_cbranch_vccz L1_ovf1
    s_mov_b64 exec, vcc
    ds_add_rtn_u32 v77, v83, v84 offset:55552
    v_lshrrev_b32 v82, 16, v9
    v_add_u32 v85, 4, v71
    v_lshl_or_b32 v82, v85, 6, v82
    v_mov_b32 v85, v65
    v_mov_b32 v65, 36992
    s_waitcnt lgkmcnt(0)
    v_cmp_le_u32 vcc, 128, v77
    v_min_u32 v77, 128, v77
    v_add_u32 v77, 93952, v77
    ds_write2_b32 v77, v15, v82 offset0:0 offset1:1
    v_mov_b32 v77, 0
    s_cbranch_vccz L1_ovg1
    s_mov_b64 exec, vcc
    ds_write_b8 v85, v23 offset:57103
L1_ovg1:
    s_mov_b64 exec, -1
L1_ovf1:
    v_cmp_le_u32 vcc, s86, v78
    s_cbranch_vccz L1_ovf2
    s_mov_b64 exec, vcc
    ds_add_rtn_u32 v78, v83, v84 offset:55552
    v_lshrrev_b32 v82, 16, v10
    v_add_u32 v85, 4, v72
    v_lshl_or_b32 v82, v85, 6, v82
    v_mov_b32 v85, v66
    v_mov_b32 v66, 36992
    s_waitcnt lgkmcnt(0)
    v_cmp_le_u32 vcc, 128, v78
    v_min_u32 v78, 128, v78
    v_add_u32 v78, 93952, v78
    ds_write2_b32 v78, v16, v82 offset0:0 offset1:1
    v_mov_b32 v78, 0
    s_cbranch_vccz L1_ovg2
    s_mov_b64 exec, vcc
    ds_write_b8 v85, v23 offset:57103
L1_ovg2:
    s_mov_b64 exec, -1
L1_ovf2:
    v_cmp_le_u32 vcc, s86, v79
    s_cbranch_vccz L1_ovf3
    s_mov_b64 exec, vcc
    ds_add_rtn_u32 v79, v83, v84 offset:55552
    v_lshrrev_b32 v82, 16, v11
    v_add_u32 v85, 4, v73
    v_lshl_or_b32 v82, v85, 6, v82
    v_mov_b32 v85, v67
    v_mov_b32 v67, 36992
    s_waitcnt lgkmcnt(0)
    v_cmp_le_u32 vcc, 128, v79
    v_min_u32 v79, 128, v79
    v_add_u32 v79, 93952, v79
    ds_write2_b32 v79, v17, v82 offset0:0 offset1:1
    v_mov_b32 v79, 0
    s_cbranch_vccz L1_ovg3
    s_mov_b64 exec, vcc
    ds_write_b8 v85, v23 offset:57103
L1_ovg3:
    s_mov_b64 exec, -1
L1_ovf3:
    v_cmp_le_u32 vcc, s86, v80
    s_cbranch_vccz L1_ovf4
    s_mov_b64 exec, vcc
    ds_add_rtn_u32 v80, v83, v84 offset:55552
    v_lshrrev_b32 v82, 16, v12
    v_add_u32 v85, 4, v74
    v_lshl_or_b32 v82, v85, 6, v82
    v_mov_b32 v85, v68
    v_mov_b32 v68, 36992
    s_waitcnt lgkmcnt(0)
    v_cmp_le_u32 vcc, 128, v80
    v_min_u32 v80, 128, v80
    v_add_u32 v80, 93952, v80
    ds_write2_b32 v80, v18, v82 offset0:0 offset1:1
    v_mov_b32 v80, 0
    s_cbranch_vccz L1_ovg4
    s_mov_b64 exec, vcc
    ds_write_b8 v85, v23 offset:57103
L1_ovg4:
    s_mov_b64 exec, -1
L1_ovf4:
    s_branch L1_ovf_done
L1_gemm:
    s_sub_u32 s72, s2, 96
    s_sub_u32 s73, s72, 157
    v_lshrrev_b32 v3, 4, v164
    v_and_b32 v4, 15, v164
    s_mov_b32 s76, s72
    s_lshl_b32 s76, s76, 8
    s_cmp_gt_u32 s24, 3
    s_cbranch_scc1 L1_wld
    s_mul_i32 s77, s24, 643072
    s_add_u32 s77, s77, s76
    v_xor_b32 v7, v3, v4
    v_lshl_add_u32 v7, v7, 4, s77
    v_mul_u32_u24 v6, 40192, v3
    v_add_u32 v6, v6, v7
    v_xor_b32 v7, 64, v6
    v_xor_b32 v8, 128, v6
    v_xor_b32 v9, 192, v6
    v_add_u32 v7, 159744, v7
    v_add_u32 v8, 319488, v8
    v_add_u32 v9, 479232, v9
    s_lshl_b32 m0, s24, 12
    s_lshl_b32 s78, s24, 8
    s_add_u32 s78, s78, s72
    s_lshl_b32 s79, s72, 14
    s_add_u32 s79, s79, 18874368
    s_cmp_ge_u32 s78, 8
    v_lshl_add_u32 v10, v164, 4, s79
    v_mov_b64 v[12:13], 0
    v_mov_b64 v[14:15], 0
    s_waitcnt lgkmcnt(0)
    s_mov_b32 s60, s4
    s_mov_b32 s61, s5
    s_mov_b32 s62, 2560000
    s_mov_b32 s63, 0x00020000
    s_cbranch_scc1 L1_zf
    global_store_dwordx4 v10, v[12:15], s[22:23] offset:0 sc1
    global_store_dwordx4 v10, v[12:15], s[22:23] offset:1024 sc1
    global_store_dwordx4 v10, v[12:15], s[22:23] offset:2048 sc1
    global_store_dwordx4 v10, v[12:15], s[22:23] offset:3072 sc1
    v_add_u32 v10, 4096, v10
    global_store_dwordx4 v10, v[12:15], s[22:23] offset:0 sc1
    global_store_dwordx4 v10, v[12:15], s[22:23] offset:1024 sc1
    global_store_dwordx4 v10, v[12:15], s[22:23] offset:2048 sc1
    global_store_dwordx4 v10, v[12:15], s[22:23] offset:3072 sc1
    v_add_u32 v10, 4096, v10
    global_store_dwordx4 v10, v[12:15], s[22:23] offset:0 sc1
    global_store_dwordx4 v10, v[12:15], s[22:23] offset:1024 sc1
    global_store_dwordx4 v10, v[12:15], s[22:23] offset:2048 sc1
    global_store_dwordx4 v10, v[12:15], s[22:23] offset:3072 sc1
    v_add_u32 v10, 4096, v10
    global_store_dwordx4 v10, v[12:15], s[22:23] offset:0 sc1
    global_store_dwordx4 v10, v[12:15], s[22:23] offset:1024 sc1
    global_store_dwordx4 v10, v[12:15], s[22:23] offset:2048 sc1
    global_store_dwordx4 v10, v[12:15], s[22:23] offset:3072 sc1
L1_zf:
    buffer_load_dwordx4 v6, s[60:63], 0 offen offset:0 lds
    buffer_load_dwordx4 v7, s[60:63], 0 offen offset:1024 lds
    buffer_load_dwordx4 v8, s[60:63], 0 offen offset:2048 lds
    buffer_load_dwordx4 v9, s[60:63], 0 offen offset:3072 lds
    s_cbranch_scc1 L1_ldd
    s_lshl_b32 s79, s72, 2
    v_mov_b32 v10, s79
    v_mov_b32 v11, 1
    s_mov_b64 exec, 1
    s_waitcnt vmcnt(4)
    global_store_dword v10, v11, s[68:69] sc1
    s_mov_b64 exec, -1
    s_branch L1_ldd
L1_wld:
    v_lshlrev_b32 v5, 2, v3
    v_xor_b32 v5, v5, v4
    v_lshlrev_b32 v5, 4, v5
    v_mov_b32 v8, v3
    s_sub_u32 s77, s24, 4
    s_lshl_b32 s80, s77, 12
    s_add_u32 s79, s80, 16384
    s_movk_i32 s83, 1024
    s_cmp_lg_u32 s73, 1
    s_cbranch_scc1 L1_permd
    v_lshrrev_b32 v8, 1, v3
    v_and_b32 v9, 1, v3
    v_lshl_add_u32 v8, v9, 5, v8
    s_lshr_b32 s80, s77, 2
    s_lshl_b32 s80, s80, 14
    s_and_b32 s81, s77, 3
    s_lshl_b32 s81, s81, 11
    s_add_u32 s80, s80, s81
    s_movk_i32 s83, 512
L1_permd:
    s_add_u32 s81, s80, s83
    s_add_u32 s82, s81, s83
    s_add_u32 s83, s82, s83
    v_lshl_add_u32 v5, v8, 8, v5
    s_and_b32 s78, s73, 1
    s_cmp_lt_u32 s72, 157
    s_cselect_b32 s78, 1, s78
    s_lshl_b32 s78, s78, 15
    s_cmp_lt_u32 s73, 2
    s_waitcnt lgkmcnt(0)
    s_cselect_b32 s64, s18, s14
    s_cselect_b32 s65, s19, s15
    s_add_u32 s64, s64, s78
    s_addc_u32 s65, s65, 0
    s_mov_b32 s66, 32768
    s_mov_b32 s67, 0x00020000
    s_add_u32 m0, s79, 0
    s_nop 0
    buffer_load_dwordx4 v5, s[64:67], s80 offen lds
    s_add_u32 m0, s79, 1024
    s_nop 0
    buffer_load_dwordx4 v5, s[64:67], s81 offen lds
    s_add_u32 m0, s79, 2048
    s_nop 0
    buffer_load_dwordx4 v5, s[64:67], s82 offen lds
    s_add_u32 m0, s79, 3072
    s_nop 0
    buffer_load_dwordx4 v5, s[64:67], s83 offen lds
L1_ldd:
    s_mul_i32 s3, s2, 625
    s_add_u32 s70, s3, 640
    s_add_u32 s3, s3, 15
    s_lshr_b32 s3, s3, 4
    s_lshr_b32 s70, s70, 4
    s_sub_u32 s70, s70, s3
    s_lshl_b32 s71, s3, 8
    s_lshl_b32 s54, s70, 8
    s_mov_b32 s55, 0x00020000
    s_add_u32 s52, s4, s71
    s_addc_u32 s53, s5, 0
    s_lshl_b32 s34, s24, 10
    s_mov_b32 s44, s6
    s_mov_b32 s45, s7
    s_mov_b32 s46, 60000
    s_mov_b32 s47, 0x00020000
    s_mov_b32 s29, 0
    s_mov_b32 s30, 0
    s_mov_b32 s50, 131072
    s_mov_b32 s51, 0x00020000
    s_add_u32 s48, s22, 16777216
    s_addc_u32 s49, s23, 0
    s_and_b32 s25, s24, 1
    s_bfe_u32 s26, s24, 0x10001
    s_lshr_b32 s27, s24, 2
    s_mul_i32 s31, s24, 4192
    s_mov_b32 s77, 115200
    s_cmp_eq_u32 s27, 0
    s_cselect_b32 s77, s77, 51840
    s_cselect_b32 s57, 1, 0
    s_add_u32 s31, s31, s77
    s_lshl_b32 s85, s25, 7
    s_add_u32 s85, s85, 12578816
    s_add_u32 s40, s22, s85
    s_addc_u32 s41, s23, 16777216
    s_mov_b32 s42, 2563968
    s_mov_b32 s43, 0x00020000
    v_mov_b32 v165, 16
    v_mov_b32 v166, 0x3f80
    v_mov_b32 v24, 0
    s_mov_b32 s58, 0
    s_add_u32 s60, s22, 12582912
    s_addc_u32 s61, s23, 0
    s_mov_b32 s62, 16777216
    s_mov_b32 s63, 0x00020000
    s_lshl_b32 s77, s24, 2
    v_add_u32 v6, s77, v3
    v_xor_b32 v7, v6, v4
    v_and_b32 v7, 15, v7
    v_lshlrev_b32 v7, 4, v7
    v_lshl_add_u32 v7, v6, 8, v7
    v_add_u32 v7, 81920, v7
    v_mul_u32_u24 v6, 40192, v6
    v_lshl_add_u32 v6, v4, 4, v6
    s_add_u32 s77, s76, 1929216
    s_and_b32 s78, s24, 3
    s_cmp_gt_u32 s24, 7
    s_cbranch_scc1 L1_help
    s_bfe_u32 s79, s24, 0x10002
    v_bfe_u32 v8, v164, 2, 2
    v_and_b32 v9, 3, v164
    v_xor_b32 v10, s78, v8
    v_lshlrev_b32 v10, 6, v10
    v_lshl_add_u32 v10, v8, 8, v10
    s_cmp_ge_u32 s72, 157
    s_cbranch_scc1 L1_pack
    v_lshrrev_b32 v11, 5, v164
    v_lshl_add_u32 v10, v11, 11, v10
    v_bfe_u32 v12, v164, 4, 1
    v_and_b32 v13, 31, v164
    s_lshl_b32 s80, s79, 5
    v_add_u32 v14, s80, v13
    v_xor_b32 v15, v11, v14
    v_and_b32 v15, 15, v15
    v_lshlrev_b32 v15, 4, v15
    v_lshl_add_u32 v15, v14, 8, v15
    s_mov_b32 s82, 3216550459
    s_mov_b32 s83, 3216550459
    v_and_b32 v18, 1, v9
    v_lshrrev_b32 v19, 1, v9
    v_lshl_add_u32 v10, v18, 5, v10
    v_lshl_add_u32 v10, v12, 4, v10
    v_lshl_add_u32 v10, v19, 3, v10
    s_lshl_b32 s80, s78, 2
    v_lshl_add_u32 v17, v11, 1, s80
    v_xor_b32 v17, v17, v14
    v_and_b32 v17, 15, v17
    v_lshlrev_b32 v17, 4, v17
    v_lshl_add_u32 v17, v14, 8, v17
    v_add_u32 v17, 81920, v17
    v_xor_b32 v18, 16, v17
    v_xor_b32 v21, 32, v15
    v_xor_b32 v22, 64, v15
    v_xor_b32 v23, 96, v15
    v_xor_b32 v24, 128, v15
    v_xor_b32 v25, 160, v15
    v_xor_b32 v26, 192, v15
    v_xor_b32 v27, 224, v15
    s_waitcnt vmcnt(0)
    s_barrier
    v_lshlrev_b32 v112, 4, v164
    v_lshrrev_b32 v113, 4, v0
    v_xor_b32 v114, v113, v0
    v_and_b32 v114, 15, v114
    v_lshlrev_b32 v114, 4, v114
    v_lshl_add_u32 v113, v113, 8, v114
    s_cmp_lg_u32 s24, 11
    s_cbranch_scc1 L2_nwr2
    v_and_b32 v114, 16, v164
    v_lshlrev_b32 v114, 2, v114
    v_xor_b32 v114, v114, v112
    v_add_u32 v115, -512, v112
    s_add_u32 s94, s14, 65536
    s_addc_u32 s95, s15, 0
    s_mov_b32 m0, 67840
    s_mov_b32 exec_hi, 0
    global_load_lds_dwordx4 v114, s[94:95]
    s_mov_b32 exec_lo, 0
    s_mov_b32 exec_hi, 0xffff
    global_load_lds_dwordx4 v115, s[16:17]
    s_mov_b64 exec, -1
L2_nwr2:
    s_add_u32 m0, s34, 55552
    s_nop 0
    buffer_load_dwordx4 v113, s[52:55], 0 offen lds
    s_mul_i32 s89, s24, 5120
    s_add_u32 m0, s89, 102144
    s_nop 0
    buffer_load_dwordx4 v112, s[44:47], s89 offen offset:0 lds
    buffer_load_dwordx4 v112, s[44:47], s89 offen offset:1024 lds
    buffer_load_dwordx4 v112, s[44:47], s89 offen offset:2048 lds
    buffer_load_dwordx4 v112, s[44:47], s89 offen offset:3072 lds
    s_add_u32 s89, s89, 4096
    s_min_u32 s89, s89, 59392
    s_add_u32 m0, s89, 102144
    s_nop 0
    buffer_load_dwordx4 v112, s[44:47], s89 offen lds
    ds_read_b128 v[64:67], v15
    ds_read_b64_tr_b16 v[32:33], v10 offset:16384
    ds_read_b64_tr_b16 v[34:35], v10 offset:17408
    ds_read_b128 v[68:71], v21
    ds_read_b64_tr_b16 v[36:37], v10 offset:20480
    ds_read_b64_tr_b16 v[38:39], v10 offset:21504
    ds_read_b128 v[72:75], v22
    ds_read_b64_tr_b16 v[40:41], v10 offset:24576
    ds_read_b64_tr_b16 v[42:43], v10 offset:25600
    ds_read_b128 v[76:79], v23
    ds_read_b64_tr_b16 v[44:45], v10 offset:28672
    ds_read_b64_tr_b16 v[46:47], v10 offset:29696
    ds_read_b128 v[80:83], v24
    ds_read_b64_tr_b16 v[48:49], v10 offset:32768
    ds_read_b64_tr_b16 v[50:51], v10 offset:33792
    ds_read_b128 v[84:87], v25
    ds_read_b64_tr_b16 v[52:53], v10 offset:36864
    ds_read_b64_tr_b16 v[54:55], v10 offset:37888
    ds_read_b128 v[88:91], v26
    ds_read_b64_tr_b16 v[56:57], v10 offset:40960
    ds_read_b64_tr_b16 v[58:59], v10 offset:41984
    ds_read_b128 v[92:95], v27
    ds_read_b64_tr_b16 v[60:61], v10 offset:45056
    ds_read_b64_tr_b16 v[62:63], v10 offset:46080
    s_waitcnt lgkmcnt(15)
    v_mfma_f32_32x32x16_bf16 v[96:111], v[32:35], v[64:67], 0
    s_waitcnt lgkmcnt(15)
    v_mfma_f32_32x32x16_bf16 v[96:111], v[36:39], v[68:71], v[96:111]
    s_waitcnt lgkmcnt(15)
    v_mfma_f32_32x32x16_bf16 v[96:111], v[40:43], v[72:75], v[96:111]
    s_waitcnt lgkmcnt(12)
    v_mfma_f32_32x32x16_bf16 v[96:111], v[44:47], v[76:79], v[96:111]
    s_waitcnt lgkmcnt(9)
    v_mfma_f32_32x32x16_bf16 v[96:111], v[48:51], v[80:83], v[96:111]
    s_waitcnt lgkmcnt(6)
    v_mfma_f32_32x32x16_bf16 v[96:111], v[52:55], v[84:87], v[96:111]
    s_waitcnt lgkmcnt(3)
    v_mfma_f32_32x32x16_bf16 v[96:111], v[56:59], v[88:91], v[96:111]
    s_waitcnt lgkmcnt(0)
    v_mfma_f32_32x32x16_bf16 v[96:111], v[60:63], v[92:95], v[96:111]
    s_nop 11
    v_pk_mul_f32 v[96:97], v[96:97], s[82:83]
    v_pk_mul_f32 v[98:99], v[98:99], s[82:83]
    v_pk_mul_f32 v[100:101], v[100:101], s[82:83]
    v_pk_mul_f32 v[102:103], v[102:103], s[82:83]
    v_pk_mul_f32 v[104:105], v[104:105], s[82:83]
    v_pk_mul_f32 v[106:107], v[106:107], s[82:83]
    v_pk_mul_f32 v[108:109], v[108:109], s[82:83]
    v_pk_mul_f32 v[110:111], v[110:111], s[82:83]
    v_cvt_pk_bf16_f32 v96, v96, v97
    v_cvt_pk_bf16_f32 v97, v98, v99
    v_cvt_pk_bf16_f32 v98, v100, v101
    v_cvt_pk_bf16_f32 v99, v102, v103
    v_cvt_pk_bf16_f32 v100, v104, v105
    v_cvt_pk_bf16_f32 v101, v106, v107
    v_cvt_pk_bf16_f32 v102, v108, v109
    v_cvt_pk_bf16_f32 v103, v110, v111
    ds_write_b128 v17, v[96:99]
    ds_write_b128 v18, v[100:103]
    s_waitcnt lgkmcnt(0)
L1_gst:
    s_barrier
    ds_read_b128 v[96:99], v7
    ds_read_b128 v[100:103], v7 offset:12288
    v_add_u32 v24, s76, v6
    s_mov_b32 s58, 1929216
L1_gend:
    v_mov_b64 v[108:109], 0
    v_mov_b64 v[110:111], 0
    v_lshrrev_b32 v1, 1, v167
    ds_write_b128 v167, v[108:111] offset:0
    ds_write_b128 v167, v[108:111] offset:12288
    ds_write_b128 v167, v[108:111] offset:24576
    ds_write_b128 v167, v[108:111] offset:36864
    v_cmp_eq_u32 vcc, 5536, v1
    v_mov_b32 v44, 0
    v_mov_b32 v45, 0x1000000
    v_cndmask_b32 v45, 0, v45, vcc
    v_cmp_gt_u32 vcc, 5632, v1
    s_mov_b64 exec, vcc
    ds_write_b64 v1, v[44:45] offset:49152
    s_mov_b64 exec, -1
    s_branch L1_end
L1_help:
    s_waitcnt vmcnt(0)
    s_barrier
    v_lshlrev_b32 v112, 4, v164
    v_lshrrev_b32 v113, 4, v0
    v_xor_b32 v114, v113, v0
    v_and_b32 v114, 15, v114
    v_lshlrev_b32 v114, 4, v114
    v_lshl_add_u32 v113, v113, 8, v114
    s_cmp_lg_u32 s24, 11
    s_cbranch_scc1 L2_nwr3
    v_and_b32 v114, 16, v164
    v_lshlrev_b32 v114, 2, v114
    v_xor_b32 v114, v114, v112
    v_add_u32 v115, -512, v112
    s_add_u32 s94, s14, 65536
    s_addc_u32 s95, s15, 0
    s_mov_b32 m0, 67840
    s_mov_b32 exec_hi, 0
    global_load_lds_dwordx4 v114, s[94:95]
    s_mov_b32 exec_lo, 0
    s_mov_b32 exec_hi, 0xffff
    global_load_lds_dwordx4 v115, s[16:17]
    s_mov_b64 exec, -1
L2_nwr3:
    s_add_u32 m0, s34, 55552
    s_nop 0
    buffer_load_dwordx4 v113, s[52:55], 0 offen lds
    s_mul_i32 s89, s24, 5120
    s_add_u32 m0, s89, 102144
    s_nop 0
    buffer_load_dwordx4 v112, s[44:47], s89 offen offset:0 lds
    buffer_load_dwordx4 v112, s[44:47], s89 offen offset:1024 lds
    buffer_load_dwordx4 v112, s[44:47], s89 offen offset:2048 lds
    buffer_load_dwordx4 v112, s[44:47], s89 offen offset:3072 lds
    s_add_u32 s89, s89, 4096
    s_min_u32 s89, s89, 59392
    s_add_u32 m0, s89, 102144
    s_nop 0
    buffer_load_dwordx4 v112, s[44:47], s89 offen lds
    s_cmp_ge_u32 s72, 157
    s_cbranch_scc0 L1_gst
    s_barrier
    s_branch L1_gend
L1_pack:
    v_lshl_add_u32 v10, v3, 11, v10
    v_lshl_add_u32 v10, v9, 4, v10
    s_lshl_b32 s80, s79, 3
    v_add_u32 v10, s80, v10
    s_lshl_b32 s81, s78, 15
    s_lshl_b32 s82, s79, 14
    s_add_u32 s81, s81, s82
    s_lshl_b32 s82, s73, 12
    s_add_u32 s81, s81, s82
    s_add_u32 s81, s81, 4194304
    v_lshlrev_b32 v17, 4, v164
    s_waitcnt vmcnt(0)
    s_barrier
    ds_read_b64_tr_b16 v[32:33], v10 offset:16384
    ds_read_b64_tr_b16 v[34:35], v10 offset:17408
    ds_read_b64_tr_b16 v[36:37], v10 offset:24576
    ds_read_b64_tr_b16 v[38:39], v10 offset:25600
    ds_read_b64_tr_b16 v[40:41], v10 offset:32768
    ds_read_b64_tr_b16 v[42:43], v10 offset:33792
    ds_read_b64_tr_b16 v[44:45], v10 offset:40960
    ds_read_b64_tr_b16 v[46:47], v10 offset:41984
    s_waitcnt lgkmcnt(6)
    buffer_store_dwordx4 v[32:35], v17, s[60:63], s81 offen offset:0 sc1
    s_waitcnt lgkmcnt(4)
    buffer_store_dwordx4 v[36:39], v17, s[60:63], s81 offen offset:1024 sc1
    s_waitcnt lgkmcnt(2)
    buffer_store_dwordx4 v[40:43], v17, s[60:63], s81 offen offset:2048 sc1
    s_waitcnt lgkmcnt(0)
    buffer_store_dwordx4 v[44:47], v17, s[60:63], s81 offen offset:3072 sc1
    v_lshlrev_b32 v112, 4, v164
    v_lshrrev_b32 v113, 4, v0
    v_xor_b32 v114, v113, v0
    v_and_b32 v114, 15, v114
    v_lshlrev_b32 v114, 4, v114
    v_lshl_add_u32 v113, v113, 8, v114
    s_cmp_lg_u32 s24, 11
    s_cbranch_scc1 L2_nwr4
    v_and_b32 v114, 16, v164
    v_lshlrev_b32 v114, 2, v114
    v_xor_b32 v114, v114, v112
    v_add_u32 v115, -512, v112
    s_add_u32 s94, s14, 65536
    s_addc_u32 s95, s15, 0
    s_mov_b32 m0, 67840
    s_mov_b32 exec_hi, 0
    global_load_lds_dwordx4 v114, s[94:95]
    s_mov_b32 exec_lo, 0
    s_mov_b32 exec_hi, 0xffff
    global_load_lds_dwordx4 v115, s[16:17]
    s_mov_b64 exec, -1
L2_nwr4:
    s_add_u32 m0, s34, 55552
    s_nop 0
    buffer_load_dwordx4 v113, s[52:55], 0 offen lds
    s_mul_i32 s89, s24, 5120
    s_add_u32 m0, s89, 102144
    s_nop 0
    buffer_load_dwordx4 v112, s[44:47], s89 offen offset:0 lds
    buffer_load_dwordx4 v112, s[44:47], s89 offen offset:1024 lds
    buffer_load_dwordx4 v112, s[44:47], s89 offen offset:2048 lds
    buffer_load_dwordx4 v112, s[44:47], s89 offen offset:3072 lds
    s_add_u32 s89, s89, 4096
    s_min_u32 s89, s89, 59392
    s_add_u32 m0, s89, 102144
    s_nop 0
    buffer_load_dwordx4 v112, s[44:47], s89 offen lds
    s_barrier
    s_branch L1_gend
L2_fixed:
    s_add_u32 s79, s27, 2
    s_sub_u32 s82, s27, 1
    s_cmp_eq_u32 s27, 0
    s_cselect_b32 s79, s79, s82
    s_mul_i32 s82, s26, 3
    s_add_u32 s79, s79, s82
    s_lshl_b32 s79, s79, 3
    s_add_u32 s28, s79, 1
    s_add_u32 s82, s79, 8
    v_readlane_b32 s94, v20, s79
    v_readlane_b32 s95, v20, s82
    s_min_u32 s95, s95, s80
    s_cmp_eq_u32 s94, s95
    s_cselect_b32 s82, 0, 511
    s_add_u32 s95, s95, s82
    s_andn2_b32 s94, s94, 511
    s_andn2_b32 s95, s95, 511
    s_branch L2_chdone
L2_ov2:
    ds_bpermute_b32 v13, v13, v21
    ds_bpermute_b32 v14, v14, v21
    s_waitcnt lgkmcnt(0)
    s_mov_b64 exec, s[66:67]
    v_add_u32 v18, v18, v13
    ds_write_b64 v18, v[102:103]
    s_mov_b64 exec, s[68:69]
    v_add_u32 v19, v19, v14
    ds_write_b64 v19, v[104:105]
    s_mov_b64 exec, -1
    s_branch L2_ov2_done
L2_chfix:
    s_add_u32 s67, s64, 511
    s_andn2_b32 s67, s67, 511
    s_min_u32 s67, s67, s77
    s_add_u32 s68, s83, 8
    s_min_u32 s68, s68, 41
    s_add_u32 s79, s68, 7
    v_readlane_b32 s69, v20, s79
    s_cmp_ge_u32 s69, s78
    s_cbranch_scc1 L2_chsel
    s_add_u32 s66, s81, 511
    s_andn2_b32 s66, s66, 511
    s_min_u32 s66, s66, s77
    s_add_u32 s83, s28, 8
    s_min_u32 s83, s83, 41
    s_add_u32 s79, s83, 7
    v_readlane_b32 s64, v20, s79
    s_andn2_b32 s65, s64, 511
    s_min_u32 s65, s65, s77
    s_add_u32 s67, s64, 511
    s_andn2_b32 s67, s67, 511
    s_min_u32 s67, s67, s77
    s_add_u32 s68, s83, 8
    s_min_u32 s68, s68, 41
    s_branch L2_chsel
L2_done2:
    s_cmp_lg_u32 s29, 0
    s_cbranch_scc1 L2_slownext
L2_flush:
L2_flw:
    v_mov_b32 v158, 0
    v_and_b32 v160, 31, v164
    s_lshl_b32 s72, s25, 7
    s_add_u32 s76, s72, 68352
    v_lshl_add_u32 v161, v160, 1, s76
    v_mov_b64 v[162:163], 0
    ds_read_b32 v159, v158 offset:54780
    v_lshrrev_b32 v157, 5, v164
    s_mul_i32 s77, s28, 272
    s_add_u32 s77, s77, s72
    s_add_u32 s77, s77, 101872
    ds_read_u16_d16_hi v162, v161
    ds_read_u16_d16_hi v163, v161 offset:64
    v_lshl_add_u32 v160, v160, 2, s77
    v_subrev_u32 v157, s28, v157
    s_movk_i32 s76, 272
    v_and_b32 v112, 7, v157
    v_mad_u32_u24 v112, v112, s76, v160
    v_add_u32 v113, 2, v157
    v_and_b32 v113, 7, v113
    v_mad_u32_u24 v113, v113, s76, v160
    v_add_u32 v114, 4, v157
    v_and_b32 v114, 7, v114
    v_mad_u32_u24 v114, v114, s76, v160
    v_add_u32 v115, 6, v157
    v_and_b32 v115, 7, v115
    v_mad_u32_u24 v115, v115, s76, v160
    s_and_b32 s56, s60, s62
    s_and_b32 s58, s64, s66
    s_andn2_b32 s58, s58, s56
    s_cmp_lg_u32 s73, 0
    s_cselect_b32 s56, -1, s56
    s_cselect_b32 s58, 0, s58
    s_mov_b32 s76, 1065375697
    s_waitcnt lgkmcnt(0)
    v_cmp_gt_u32 vcc, 192, v159
    s_cbranch_vccnz L2_flw
    s_branch L2_t1
L2_zero:
    s_cmp_lg_u32 s27, 0
    s_cbranch_scc1 L2_done2
    v_lshlrev_b32 v160, 4, v164
    s_lshl_b32 s72, s24, 15
    s_add_u32 s78, s24, 0
    s_and_b32 s78, s78, 3
    s_lshl_b32 s82, s78, 6
    s_lshl_b32 s78, s78, 10
    s_add_u32 s78, s78, s72
    s_add_u32 s86, s78, 16384
    buffer_load_dwordx4 v[96:99], v160, s[48:51], s78 offen sc1
    buffer_load_dwordx4 v[128:131], v160, s[48:51], s86 offen sc1
    s_add_u32 s79, s24, 1
    s_and_b32 s79, s79, 3
    s_lshl_b32 s83, s79, 6
    s_lshl_b32 s79, s79, 10
    s_add_u32 s79, s79, s72
    s_add_u32 s87, s79, 16384
    buffer_load_dwordx4 v[100:103], v160, s[48:51], s79 offen sc1
    buffer_load_dwordx4 v[132:135], v160, s[48:51], s87 offen sc1
    s_add_u32 s80, s24, 2
    s_and_b32 s80, s80, 3
    s_lshl_b32 s84, s80, 6
    s_lshl_b32 s80, s80, 10
    s_add_u32 s80, s80, s72
    s_add_u32 s88, s80, 16384
    buffer_load_dwordx4 v[104:107], v160, s[48:51], s80 offen sc1
    buffer_load_dwordx4 v[136:139], v160, s[48:51], s88 offen sc1
    s_add_u32 s81, s24, 3
    s_and_b32 s81, s81, 3
    s_lshl_b32 s85, s81, 6
    s_lshl_b32 s81, s81, 10
    s_add_u32 s81, s81, s72
    s_add_u32 s89, s81, 16384
    buffer_load_dwordx4 v[108:111], v160, s[48:51], s81 offen sc1
    buffer_load_dwordx4 v[140:143], v160, s[48:51], s89 offen sc1
    s_add_u32 s76, s72, 4096
    s_add_u32 s77, s72, 20480
    buffer_load_dwordx4 v[144:147], v160, s[48:51], s76 offen offset:0 sc1
    buffer_load_dwordx4 v[148:151], v160, s[48:51], s76 offen offset:1024 sc1
    buffer_load_dwordx4 v[152:155], v160, s[48:51], s76 offen offset:2048 sc1
    buffer_load_dwordx4 v[116:119], v160, s[48:51], s76 offen offset:3072 sc1
    buffer_load_dwordx4 v[0:3], v160, s[48:51], s77 offen offset:0 sc1
    buffer_load_dwordx4 v[4:7], v160, s[48:51], s77 offen offset:1024 sc1
    buffer_load_dwordx4 v[8:11], v160, s[48:51], s77 offen offset:2048 sc1
    buffer_load_dwordx4 v[12:15], v160, s[48:51], s77 offen offset:3072 sc1
    s_branch L2_done2
L2_fixedG:
    s_add_u32 s79, s27, 2
    s_sub_u32 s82, s27, 1
    s_cmp_eq_u32 s27, 0
    s_cselect_b32 s79, s79, s82
    s_mul_i32 s82, s26, 3
    s_add_u32 s79, s79, s82
    s_lshl_b32 s79, s79, 3
    s_add_u32 s28, s79, 1
    s_add_u32 s82, s79, 8
    v_readlane_b32 s94, v20, s79
    v_readlane_b32 s95, v20, s82
    s_min_u32 s95, s95, s80
    s_cmp_eq_u32 s94, s95
    s_cselect_b32 s82, 0, 511
    s_add_u32 s95, s95, s82
    s_andn2_b32 s94, s94, 511
    s_andn2_b32 s95, s95, 511
    s_branch L2_chdoneG
L2_ov2G:
    ds_bpermute_b32 v13, v13, v21
    ds_bpermute_b32 v14, v14, v21
    s_waitcnt lgkmcnt(0)
    s_mov_b64 exec, s[66:67]
    v_add_u32 v18, v18, v13
    ds_write_b64 v18, v[102:103]
    s_mov_b64 exec, s[68:69]
    v_add_u32 v19, v19, v14
    ds_write_b64 v19, v[104:105]
    s_mov_b64 exec, -1
    s_branch L2_ov2_doneG
L2_chfixG:
    s_add_u32 s67, s64, 511
    s_andn2_b32 s67, s67, 511
    s_min_u32 s67, s67, s77
    s_add_u32 s68, s83, 8
    s_min_u32 s68, s68, 41
    s_add_u32 s79, s68, 7
    v_readlane_b32 s69, v20, s79
    s_cmp_ge_u32 s69, s78
    s_cbranch_scc1 L2_chselG
    s_add_u32 s66, s81, 511
    s_andn2_b32 s66, s66, 511
    s_min_u32 s66, s66, s77
    s_add_u32 s83, s28, 8
    s_min_u32 s83, s83, 41
    s_add_u32 s79, s83, 7
    v_readlane_b32 s64, v20, s79
    s_andn2_b32 s65, s64, 511
    s_min_u32 s65, s65, s77
    s_add_u32 s67, s64, 511
    s_andn2_b32 s67, s67, 511
    s_min_u32 s67, s67, s77
    s_add_u32 s68, s83, 8
    s_min_u32 s68, s68, 41
    s_branch L2_chselG
L2_poll2:
    s_mov_b32 s78, 0
L2_poll2r:
    global_load_dword v51, v31, s[22:23] sc1
    s_add_u32 s78, s78, 1
    s_cmp_gt_u32 s78, 32768
    s_waitcnt vmcnt(0)
    v_cmp_eq_u32 vcc, 0, v51
    s_cbranch_scc1 L2_poll2d
    s_cbranch_vccz L2_poll2d
    s_sleep 1
    s_branch L2_poll2r
L2_poll2G:
    s_mov_b32 s78, 0
L2_poll2rG:
    global_load_dword v51, v31, s[22:23] sc1
    s_add_u32 s78, s78, 1
    s_cmp_gt_u32 s78, 32768
    s_waitcnt vmcnt(0)
    v_cmp_eq_u32 vcc, 0, v51
    s_cbranch_scc1 L2_poll2dG
    s_cbranch_vccz L2_poll2dG
    s_sleep 1
    s_branch L2_poll2rG
L2_tb2:
    s_mul_i32 s89, s24, 5120
    s_add_u32 m0, s89, 102144
    s_nop 0
    buffer_load_dwordx4 v30, s[44:47], s89 offen offset:0 lds
    buffer_load_dwordx4 v30, s[44:47], s89 offen offset:1024 lds
    buffer_load_dwordx4 v30, s[44:47], s89 offen offset:2048 lds
    buffer_load_dwordx4 v30, s[44:47], s89 offen offset:3072 lds
    s_add_u32 s89, s89, 4096
    s_min_u32 s89, s89, 59392
    s_add_u32 m0, s89, 102144
    s_nop 0
    buffer_load_dwordx4 v30, s[44:47], s89 offen lds
    s_waitcnt vmcnt(5)
    s_branch L2_p1b
L2_bst:
    s_cmp_eq_u32 s58, 0
    s_cbranch_scc1 L2_cl
    buffer_store_dwordx4 v[96:99], v24, s[60:63], 0 offen sc1
    s_cmp_gt_u32 s24, 3
    s_cbranch_scc1 L2_cl
    buffer_store_dwordx4 v[100:103], v24, s[60:63], s58 offen sc1
    s_branch L2_cl
L2_ack:
    global_load_dword v26, v27, s[22:23] sc1
    v_lshl_add_u32 v24, v164, 14, s87
    s_mov_b64 exec, 1
    s_cmp_gt_u32 s24, 3
    s_waitcnt vmcnt(1)
    s_cbranch_scc0 L2_ack1
    s_waitcnt vmcnt(1)
L2_ack1:
    ds_add_rtn_u32 v25, v108, v165 offset:54752
    s_waitcnt lgkmcnt(0)
    v_cmp_eq_u32 vcc, 176, v25
    s_mov_b64 exec, -1
    s_cbranch_vccz L2_pollw
    s_mov_b64 exec, 0xff
    global_store_dword v24, v165, s[22:23] sc1
    s_mov_b64 exec, -1
    s_waitcnt vmcnt(1)
    s_branch L2_pollc
L2_ov1:
    s_cbranch_vccz L2_nolost
    v_mov_b32 v1, 0x100000
    ds_write_b32 v108, v1 offset:54528
L2_nolost:
    v_and_b32 v13, 0xfc, v6
    v_and_b32 v14, 0xfc, v8
    s_mov_b64 exec, s[66:67]
    ds_add_rtn_u32 v18, v13, v165 offset:54528
    s_mov_b64 exec, s[68:69]
    ds_add_rtn_u32 v19, v14, v165 offset:54528
    s_mov_b64 exec, -1
    v_perm_b32 v102, v7, v6, s81
    v_mov_b32 v103, v6
    v_perm_b32 v104, v9, v8, s81
    v_mov_b32 v105, v8
    s_branch L2_ov1_done
L2_slownext:
    s_mov_b32 s29, 1
    s_add_u32 s30, s30, 768
    s_cmp_ge_u32 s30, 320000
    s_cbranch_scc1 L2_flush
L2_goslow:
    s_add_u32 s29, s29, 1
    s_waitcnt vmcnt(0) lgkmcnt(0)
    s_barrier
    v_lshlrev_b32 v30, 4, v164
    s_mul_i32 s89, s24, 5120
    s_add_u32 m0, s89, 102144
    s_nop 0
    buffer_load_dwordx4 v30, s[44:47], s89 offen offset:0 lds
    buffer_load_dwordx4 v30, s[44:47], s89 offen offset:1024 lds
    buffer_load_dwordx4 v30, s[44:47], s89 offen offset:2048 lds
    buffer_load_dwordx4 v30, s[44:47], s89 offen offset:3072 lds
    s_add_u32 s89, s89, 4096
    s_min_u32 s89, s89, 59392
    s_add_u32 m0, s89, 102144
    s_nop 0
    buffer_load_dwordx4 v30, s[44:47], s89 offen lds
    v_mov_b64 v[108:109], 0
    v_mov_b64 v[110:111], 0
    v_lshrrev_b32 v1, 1, v167
    ds_write_b128 v167, v[108:111] offset:0
    ds_write_b128 v167, v[108:111] offset:12288
    ds_write_b128 v167, v[108:111] offset:24576
    ds_write_b128 v167, v[108:111] offset:36864
    v_cmp_eq_u32 vcc, 5536, v1
    v_mov_b32 v44, 0
    v_mov_b32 v45, 0x1000000
    v_cndmask_b32 v45, 0, v45, vcc
    v_cmp_gt_u32 vcc, 5632, v1
    s_mov_b64 exec, vcc
    ds_write_b64 v1, v[44:45] offset:49152
    s_mov_b64 exec, -1
    v_and_b32 v119, 31, v164
    v_lshrrev_b32 v116, 5, v164
    v_lshlrev_b32 v120, 3, v116
    v_sub_u32 v119, v119, v120
    v_and_b32 v120, 1, v119
    v_lshlrev_b32 v120, 4, v120
    v_lshlrev_b32 v120, v120, v166
    v_ashrrev_i32 v119, 1, v119
    v_cmp_eq_u32 vcc, 0, v119
    s_nop 1
    v_cndmask_b32 v128, 0, v120, vcc
    v_cmp_eq_u32 vcc, 1, v119
    s_nop 1
    v_cndmask_b32 v129, 0, v120, vcc
    v_cmp_eq_u32 vcc, 2, v119
    s_nop 1
    v_cndmask_b32 v130, 0, v120, vcc
    v_cmp_eq_u32 vcc, 3, v119
    s_nop 1
    v_cndmask_b32 v131, 0, v120, vcc
    v_cmp_eq_u32 vcc, 8, v119
    s_nop 1
    v_cndmask_b32 v132, 0, v120, vcc
    v_cmp_eq_u32 vcc, 9, v119
    s_nop 1
    v_cndmask_b32 v133, 0, v120, vcc
    v_cmp_eq_u32 vcc, 10, v119
    s_nop 1
    v_cndmask_b32 v134, 0, v120, vcc
    v_cmp_eq_u32 vcc, 11, v119
    s_nop 1
    v_cndmask_b32 v135, 0, v120, vcc
    v_and_b32 v119, 7, v164
    v_xor_b32 v120, v119, v116
    v_lshlrev_b32 v157, 4, v120
    v_mov_b32 v156, 0xdddddddd
    v_and_b32 v121, 8, v164
    v_and_b32 v122, 3, v164
    v_lshl_add_u32 v122, v122, 1, v121
    v_bfe_u32 v121, v164, 4, 1
    v_add_u32 v122, v122, v121
    v_bfe_u32 v123, v164, 2, 1
    v_lshl_add_u32 v122, v122, 1, v123
    v_xor_b32 v123, 1, v116
    v_mul_u32_u24 v123, 29952, v123
    v_lshl_add_u32 v158, v122, 4, v123
    v_lshrrev_b32 v123, 3, v122
    v_mul_u32_u24 v123, 1056, v123
    v_and_b32 v122, 7, v122
    v_lshl_add_u32 v123, v122, 7, v123
    v_and_b32 v120, 1, v120
    v_lshl_add_u32 v161, v120, 4, v123
    v_lshrrev_b32 v120, 3, v164
    v_lshlrev_b32 v160, 4, v120
    v_and_b32 v119, 3, v164
    v_lshl_add_u32 v117, v121, 2, v119
    v_bfe_u32 v118, v164, 2, 2
    v_lshl_add_u32 v121, v116, 2, v118
    v_lshl_add_u32 v159, v121, 6, 8
    v_lshlrev_b32 v162, 2, v117
    v_sub_u32 v163, 28, v162
    s_lshl_b32 s80, s25, 1
    v_sub_u32 v144, 7, v118
    v_lshlrev_b32 v144, 8, v144
    v_mov_b32 v145, 0xfffff800
    v_add_u32 v119, 3, v118
    v_sub_u32 v119, v119, v116
    v_and_b32 v119, 3, v119
    v_xor_b32 v119, s80, v119
    v_lshl_add_u32 v119, v118, 2, v119
    v_lshlrev_b32 v119, 6, v119
    v_lshl_add_u32 v146, v117, 3, v119
    v_add_u32 v147, 1024, v146
    s_mov_b32 exec_lo, 0
    v_mov_b32 v145, 0
    v_add_u32 v146, 67328, v146
    v_mov_b32 v147, 54704
    s_mov_b32 exec_hi, 0x00ff00ff
    v_mov_b32 v146, 54704
    s_mov_b64 exec, -1
    v_add_u32 v161, s31, v161
    v_mov_b32 v149, v157
    v_mov_b32 v151, v157
    v_mov_b32 v153, v157
    v_mov_b32 v155, v157
    v_lshrrev_b32 v1, 4, v167
    v_add_u32 v1, s30, v1
    v_min_u32 v3, 319999, v1
    v_lshlrev_b32 v4, 2, v3
    v_lshlrev_b32 v3, 1, v3
    global_load_dword v7, v4, s[12:13]
    global_load_dword v8, v4, s[10:11]
    global_load_ushort v6, v3, s[8:9]
    s_mov_b32 s73, 320000
    s_mov_b32 s76, 0x05040100
    v_cmp_gt_u32 s[60:61], s73, v1
    s_waitcnt vmcnt(0)
    v_subrev_u32 v7, s3, v7
    v_cmp_gt_u32 s[62:63], s70, v7
    v_lshl_add_u32 v7, v8, 6, v7
    v_lshl_add_u32 v7, v7, 2, 4
    v_lshlrev_b32 v6, 16, v6
    v_mul_f32 v6, 3216550459, v6
    v_cvt_pk_bf16_f32 v6, v6, v6
    v_perm_b32 v7, v6, v7, s76
    s_and_b64 s[60:61], s[60:61], s[62:63]
    v_cndmask_b32 v2, 0, v7, s[60:61]
    v_lshrrev_b32 v5, 8, v8
    v_mov_b64 v[6:7], 0
    v_mov_b64 v[8:9], 0
    v_mov_b32 v3, 0
    v_mov_b32 v4, 0
    s_branch L2_batch
.section .rodata,"a"
.p2align 6
.amdhsa_kernel kf_kernel
  .amdhsa_next_free_vgpr 168
  .amdhsa_next_free_sgpr 102
  .amdhsa_accum_offset 168
  .amdhsa_group_segment_fixed_size 0
  .amdhsa_kernarg_size 88
  .amdhsa_user_sgpr_count 2
  .amdhsa_user_sgpr_kernarg_segment_ptr 1
  .amdhsa_system_sgpr_workgroup_id_x 1
.end_amdhsa_kernel
```
